```python
import torch

def _softmax(x, axis=-1):
    return torch.softmax(x, dim=axis)

def _gelu(x):
    return torch.nn.functional.gelu(x, approximate='tanh')

def _silu(x):
    return torch.nn.functional.silu(x)

def _sigmoid(x):
    return torch.sigmoid(x)

def _layernorm(x, axis=-1, eps=1e-05):
    m = x.mean(dim=axis, keepdim=True)
    v = x.var(dim=axis, keepdim=True, unbiased=False)
    return (x - m) / torch.sqrt(v + eps)

def _scatter_add(tgt, idx, src, axis=0):
    return tgt.clone().index_add_(axis, idx, src)

def _segment_sum(src, seg, n):
    out = torch.zeros((n,) + src.shape[1:], dtype=src.dtype)
    return out.index_add_(0, seg, src)

def _pad(x, pw):
    flat = tuple((v for pair in reversed(pw) for v in pair))
    return torch.nn.functional.pad(x, flat)
kernel_name = 'recurrent_scan__softmax_full_mha__mixer_gmlp__prompt'

def setup_inputs():

    _w = lambda a: (lambda t: t.to(torch.bfloat16) if t.is_floating_point() else t)(torch.as_tensor(a))

    def _A_setup():
        B, S, D = (1, 2048, 512)
        return {'x': _w((lambda *s: torch.randn(*s, dtype=torch.bfloat16) * 0.05)(B, S, D)), 'wqkv': _w((lambda *s: torch.randn(*s, dtype=torch.bfloat16) * 0.05)(D, 3 * D)), 'wo': _w((lambda *s: torch.randn(*s, dtype=torch.bfloat16) * 0.05)(D, D))}
    _A_in = _A_setup()

    def _B_setup():
        B, S, D, F = (1, 2048, 512, 1792)
        Fh = F // 2
        return {'x': _w((lambda *s: torch.randn(*s, dtype=torch.bfloat16) * 0.05)(B, S, D)), 'w_in': _w((lambda *s: torch.randn(*s, dtype=torch.bfloat16) * 0.8)(D, 2 * Fh)), 'w_sp': _w(0.01 * (lambda *s: torch.randn(*s, dtype=torch.bfloat16) * 0.8)(S, S)), 'b_sp': _w(1.0 + 0.01 * (lambda *s: torch.randn(*s, dtype=torch.bfloat16) * 0.05)(S)), 'w_out': _w((lambda *s: torch.randn(*s, dtype=torch.bfloat16) * 0.05)(Fh, D))}
    _B_in = _B_setup()
    return {'A_x': _A_in['x'], 'A_wqkv': _A_in['wqkv'], 'A_wo': _A_in['wo'], 'B_x': _B_in['x'], 'B_w_in': _B_in['w_in'], 'B_w_sp': _B_in['w_sp'], 'B_b_sp': _B_in['b_sp'], 'B_w_out': _B_in['w_out']}

def reference(A_x, A_wqkv, A_wo, B_x, B_w_in, B_w_sp, B_b_sp, B_w_out):

    def _A_ref(x, wqkv, wo):
        B, S, D = x.shape
        H = 32
        Dh = D // H
        qkv = (lambda x, *d: x.permute(*d))((x @ wqkv).reshape(B, S, 3, H, Dh), 2, 0, 3, 1, 4)
        q, k, v = (qkv[0], qkv[1], qkv[2])
        scale = Dh ** (-0.5)
        scores = torch.einsum('bhqd,bhkd->bhqk', q, k) * scale
        p = _softmax(scores, axis=-1)
        o = torch.einsum('bhqk,bhkd->bhqd', p, v)
        return (lambda x, *d: x.permute(*d))(o, 0, 2, 1, 3).reshape(B, S, D) @ wo

    def _B_ref(x, w_in, w_sp, b_sp, w_out):
        B, S, D = x.shape
        F = w_in.shape[-1]
        Fh = F // 2
        z = _gelu(torch.einsum('bsd,df->bsf', x, w_in))
        z1 = z[..., :Fh].clone()
        z2 = _layernorm(z[..., Fh:], axis=-1)
        g = torch.einsum('ts,bsf->btf', w_sp, z2) + b_sp[None, :, None]
        return torch.einsum('bsf,fd->bsd', z1 * g, w_out)
    x = A_x
    xn = _layernorm(x, axis=-1)
    s = _A_ref(xn, A_wqkv, A_wo)
    g = _silu(_B_ref(xn, B_w_in, B_w_sp, B_b_sp, B_w_out))
    return x + s * g
```

```asm
; @launch grid=(256,1,1) block=(768,1,1) lds=163840
.amdgcn_target "amdgcn-amd-amdhsa--gfx950"
.text
.globl recurrent_scan__softmax_full_mha__mixer_gmlp__prompt_kernel
.p2align 8
.type recurrent_scan__softmax_full_mha__mixer_gmlp__prompt_kernel,@function
recurrent_scan__softmax_full_mha__mixer_gmlp__prompt_kernel:
    s_cmp_ge_u32 s2, 256
    s_cbranch_scc1 fz_end
    s_load_dwordx2 s[8:9], s[0:1], 0
    s_load_dwordx2 s[12:13], s[0:1], 8
    s_load_dwordx2 s[16:17], s[0:1], 32
    s_load_dwordx2 s[4:5], s[0:1], 80
    s_load_dwordx2 s[20:21], s[0:1], 72
    s_memrealtime s[54:55]
    v_lshrrev_b32 v16, 6, v0
    v_and_b32 v1, 63, v0
    v_readfirstlane_b32 s24, v16
    v_lshlrev_b32 v2, 4, v1
    s_mov_b32 s6, 33554432
    s_mov_b32 s7, 0x00020000
    s_mov_b32 s10, 2097152
    s_mov_b32 s11, 0x00020000
    s_mov_b32 s14, 1572864
    s_mov_b32 s15, 0x00020000
    s_mov_b32 s18, 1835008
    s_mov_b32 s19, 0x00020000
    s_mov_b32 s22, 256
    s_mov_b32 s23, 0x00020000
    s_mov_b32 s61, 200000
    s_mov_b32 s99, 0
    s_mov_b32 s98, 255
    s_and_b32 s40, s2, 31
    s_lshl_b32 s40, s40, 2
    s_add_u32 s40, s40, 128
    v_mov_b32 v166, s40
    s_cmp_lt_u32 s2, 32
    s_cbranch_scc1 k1_helper
    s_and_b32 s40, s2, 7
    s_lshr_b32 s41, s2, 3
    s_sub_u32 s41, s41, 4
    s_mul_i32 s45, s41, 37
    s_lshr_b32 s45, s45, 8
    s_mul_i32 s46, s45, 7
    s_sub_u32 s27, s41, s46
    s_and_b32 s42, s2, 1
    s_mul_i32 s46, s42, 7
    s_add_u32 s27, s27, s46
    s_lshr_b32 s26, s40, 1
    s_lshl_b32 s26, s26, 2
    s_add_u32 s26, s26, s45
    s_lshl_b32 s98, s26, 4
    s_add_u32 s98, s98, s27
    s_lshr_b32 s25, s24, 2
    s_and_b32 s28, s24, 3
    s_cmp_ge_u32 s24, 8
    s_cbranch_scc1 k1_loader
    s_lshr_b32 s34, s27, 2
    s_cmp_eq_u32 s25, 0
    s_cselect_b32 s34, 4, s34
    s_add_u32 s40, s27, 38
    s_add_u32 s41, s27, 24
    s_lshl_b32 s42, s27, 1
    s_add_u32 s43, s42, 1
    s_cmp_eq_u32 s25, 0
    s_cselect_b32 s40, s40, s42
    s_cselect_b32 s41, s41, s43
    s_lshl_b32 s38, s40, 9
    s_add_u32 s38, s38, 21037056
    s_lshl_b32 s39, s41, 9
    s_add_u32 s39, s39, 21037056
    s_lshl_b32 s36, s26, 2
    s_add_u32 s36, s36, s28
    v_and_b32 v16, 31, v1
    v_and_b32 v17, 0x13, v16
    v_and_b32 v18, 4, v16
    v_lshl_or_b32 v17, v18, 1, v17
    v_and_b32 v18, 8, v16
    v_lshrrev_b32 v18, 1, v18
    v_or_b32 v17, v17, v18
    s_cmp_eq_u32 s34, 1
    s_cselect_b64 vcc, -1, 0
    v_cndmask_b32 v16, v16, v17, vcc
    v_lshrrev_b32 v17, 5, v1
    v_bfe_u32 v18, v16, 1, 3
    v_xor_b32 v18, v18, v17
    v_lshlrev_b32 v18, 4, v18
    v_lshl_add_u32 v18, v16, 7, v18
    s_lshl_b32 s40, s28, 12
    v_add_u32 v9, s40, v18
    v_xor_b32 v10, 32, v9
    v_xor_b32 v11, 64, v9
    v_xor_b32 v12, 96, v9
    s_lshl_b32 s40, s36, 9
    s_add_u32 s40, s40, 20971520
    v_lshlrev_b32 v16, 4, v16
    v_add_u32 v164, s40, v16
    v_lshlrev_b32 v165, 3, v1
    v_bfe_u32 v16, v1, 2, 2
    v_lshl_add_u32 v17, v17, 3, v16
    v_bfe_u32 v18, v1, 4, 1
    v_lshlrev_b32 v18, 1, v18
    v_and_b32 v19, 1, v1
    v_or_b32 v18, v18, v19
    v_lshlrev_b32 v16, 1, v16
    v_and_b32 v16, 4, v16
    v_xor_b32 v18, v18, v16
    v_lshlrev_b32 v18, 4, v18
    v_lshl_add_u32 v18, v17, 7, v18
    v_bfe_u32 v19, v1, 1, 1
    v_lshl_add_u32 v18, v19, 3, v18
    v_add_u32 v13, 16384, v18
    v_xor_b32 v14, 64, v13
    s_lshl_b32 s41, s28, 12
    s_cmp_eq_u32 s25, 0
    s_cselect_b32 s42, 131072, 0
    s_add_u32 s41, s41, s42
    s_lshl_b32 s40, s24, 9
    s_add_u32 s40, s40, 147712
    v_lshlrev_b32 v16, 2, v1
    v_add_u32 v20, s40, v16
    v_lshrrev_b32 v18, 5, v1
    v_lshlrev_b32 v22, 5, v18
    v_add_u32 v22, s40, v22
    v_lshlrev_b32 v21, 3, v1
    v_mov_b32 v3, 0xc0135761
    v_and_b32 v16, 31, v1
    v_and_b32 v17, 1, v16
    v_bfe_u32 v19, v16, 1, 1
    v_lshl_or_b32 v17, v19, 2, v17
    v_bfe_u32 v19, v16, 2, 1
    v_lshl_or_b32 v17, v19, 1, v17
    v_xor_b32 v17, v17, v18
    v_lshlrev_b32 v17, 4, v17
    v_lshl_add_u32 v17, v16, 7, v17
    v_add_u32 v24, s41, v17
    v_xor_b32 v25, 32, v24
    v_xor_b32 v26, 64, v24
    v_xor_b32 v27, 96, v24
    v_bfe_u32 v16, v1, 2, 2
    v_and_b32 v17, 1, v16
    v_lshrrev_b32 v19, 1, v16
    v_lshl_or_b32 v17, v19, 2, v17
    v_bfe_u32 v19, v1, 4, 1
    v_lshlrev_b32 v19, 1, v19
    v_and_b32 v23, 1, v1
    v_or_b32 v19, v19, v23
    v_xor_b32 v17, v17, v19
    v_lshlrev_b32 v17, 4, v17
    v_lshl_add_u32 v16, v18, 3, v16
    v_lshl_add_u32 v17, v16, 7, v17
    v_bfe_u32 v19, v1, 1, 1
    v_lshl_add_u32 v17, v19, 3, v17
    v_add_u32 v28, s41, v17
    v_xor_b32 v29, 32, v28
    v_xor_b32 v30, 64, v28
    v_xor_b32 v31, 96, v28
    v_and_b32 v16, 15, v1
    v_lshlrev_b32 v16, 4, v16
    v_lshl_add_u32 v16, v18, 8, v16
    v_bfe_u32 v19, v1, 4, 1
    v_lshl_add_u32 v23, v19, 16, v16
    s_waitcnt lgkmcnt(0)
    s_cmp_eq_u32 s25, 0
    s_cbranch_scc1 k1_main
    v_lshlrev_b32 v16, 2, v1
    v_and_b32 v16, 127, v16
    v_add_u32 v16, 131072, v16
    v_mov_b32 v17, 0
    ds_write_b32 v16, v17 offset:16448
    s_waitcnt lgkmcnt(0)
    s_barrier
    s_waitcnt lgkmcnt(0)
    s_barrier
    s_waitcnt lgkmcnt(0)
    s_barrier
    buffer_load_dword v15, v166, s[20:23], 0 offen sc0 sc1
    s_waitcnt lgkmcnt(0)
    s_barrier
    s_cmp_lg_u32 s24, 4
    s_cbranch_scc1 fz_kernel_notag1
    s_branch fz_kernel_tagchk4
fz_kernel_tagpoll2:
    buffer_load_dword v15, v166, s[20:23], 0 offen sc0 sc1
fz_kernel_tagchk4:
    s_waitcnt vmcnt(0)
    v_readfirstlane_b32 s40, v15
    s_nop 0
    s_cmp_eq_u32 s40, 0
    s_cbranch_scc1 fz_kernel_tagno5
    s_sub_u32 s53, s54, s40
    s_add_u32 s53, s53, 100000
    s_cmp_lt_u32 s53, 102000
    s_cbranch_scc1 fz_kernel_tagok3
    s_cmp_lt_u32 s61, 197000
    s_cbranch_scc1 fz_kernel_tagok3
fz_kernel_tagno5:
    s_sleep 2
    s_sub_u32 s61, s61, 1
    s_cbranch_scc0 fz_kernel_tagpoll2
    s_mov_b32 s61, 0
fz_kernel_tagok3:
    v_mov_b32 v16, 147456
    ds_write_b32 v16, v15
fz_kernel_notag1:
    s_waitcnt lgkmcnt(0)
    s_barrier
    s_waitcnt lgkmcnt(0)
    s_barrier
    s_waitcnt lgkmcnt(0)
    s_barrier
    s_waitcnt lgkmcnt(0)
    s_barrier
    s_cmp_ge_u32 s27, 12
    s_cbranch_scc1 k1_fin0
    s_setprio 2
k1_main:
    s_waitcnt lgkmcnt(0)
    s_barrier
    ds_read_b128 v[96:99], v9
    ds_read_b64_tr_b16 v[108:109], v13 offset:0
    ds_read_b64_tr_b16 v[110:111], v13 offset:512
    ds_read_b64_tr_b16 v[112:113], v14 offset:0
    ds_read_b64_tr_b16 v[114:115], v14 offset:512
    ds_read_b64_tr_b16 v[116:117], v13 offset:8192
    ds_read_b64_tr_b16 v[118:119], v13 offset:8704
    ds_read_b64_tr_b16 v[120:121], v14 offset:8192
    ds_read_b64_tr_b16 v[122:123], v14 offset:8704
    ds_read_b128 v[100:103], v10
    ds_read_b64_tr_b16 v[124:125], v13 offset:2048
    ds_read_b64_tr_b16 v[126:127], v13 offset:2560
    ds_read_b64_tr_b16 v[128:129], v14 offset:2048
    ds_read_b64_tr_b16 v[130:131], v14 offset:2560
    ds_read_b64_tr_b16 v[132:133], v13 offset:10240
    ds_read_b64_tr_b16 v[134:135], v13 offset:10752
    ds_read_b64_tr_b16 v[136:137], v14 offset:10240
    ds_read_b64_tr_b16 v[138:139], v14 offset:10752
    ds_read_b128 v[104:107], v11
    v_mfma_f32_32x32x16_bf16 v[32:47], v[108:111], v[96:99], 0
    ds_read_b64_tr_b16 v[140:141], v13 offset:4096
    ds_read_b64_tr_b16 v[142:143], v13 offset:4608
    v_mfma_f32_32x32x16_bf16 v[48:63], v[112:115], v[96:99], 0
    ds_read_b64_tr_b16 v[144:145], v14 offset:4096
    ds_read_b64_tr_b16 v[146:147], v14 offset:4608
    ds_read_b64_tr_b16 v[148:149], v13 offset:12288
    v_mfma_f32_32x32x16_bf16 v[64:79], v[116:119], v[96:99], 0
    ds_read_b64_tr_b16 v[150:151], v13 offset:12800
    ds_read_b64_tr_b16 v[152:153], v14 offset:12288
    v_mfma_f32_32x32x16_bf16 v[80:95], v[120:123], v[96:99], 0
    ds_read_b64_tr_b16 v[154:155], v14 offset:12800
    v_mfma_f32_32x32x16_bf16 v[32:47], v[124:127], v[100:103], v[32:47]
    ds_read_b128 v[96:99], v12
    ds_read_b64_tr_b16 v[108:109], v13 offset:6144
    ds_read_b64_tr_b16 v[110:111], v13 offset:6656
    ds_read_b64_tr_b16 v[112:113], v14 offset:6144
    ds_read_b64_tr_b16 v[114:115], v14 offset:6656
    v_mfma_f32_32x32x16_bf16 v[48:63], v[128:131], v[100:103], v[48:63]
    ds_read_b64_tr_b16 v[116:117], v13 offset:14336
    ds_read_b64_tr_b16 v[118:119], v13 offset:14848
    ds_read_b64_tr_b16 v[120:121], v14 offset:14336
    ds_read_b64_tr_b16 v[122:123], v14 offset:14848
    v_mfma_f32_32x32x16_bf16 v[64:79], v[132:135], v[100:103], v[64:79]
    v_mfma_f32_32x32x16_bf16 v[80:95], v[136:139], v[100:103], v[80:95]
    s_waitcnt lgkmcnt(0)
    s_barrier
    v_add_u32 v9, 0x8000, v9
    v_add_u32 v10, 0x8000, v10
    v_add_u32 v11, 0x8000, v11
    v_add_u32 v12, 0x8000, v12
    v_add_u32 v13, 0x8000, v13
    v_add_u32 v14, 0x8000, v14
    ds_read_b128 v[100:103], v9
    v_mfma_f32_32x32x16_bf16 v[32:47], v[140:143], v[104:107], v[32:47]
    ds_read_b64_tr_b16 v[124:125], v13 offset:0
    ds_read_b64_tr_b16 v[126:127], v13 offset:512
    v_mfma_f32_32x32x16_bf16 v[48:63], v[144:147], v[104:107], v[48:63]
    ds_read_b64_tr_b16 v[128:129], v14 offset:0
    ds_read_b64_tr_b16 v[130:131], v14 offset:512
    ds_read_b64_tr_b16 v[132:133], v13 offset:8192
    v_mfma_f32_32x32x16_bf16 v[64:79], v[148:151], v[104:107], v[64:79]
    ds_read_b64_tr_b16 v[134:135], v13 offset:8704
    ds_read_b64_tr_b16 v[136:137], v14 offset:8192
    v_mfma_f32_32x32x16_bf16 v[80:95], v[152:155], v[104:107], v[80:95]
    ds_read_b64_tr_b16 v[138:139], v14 offset:8704
    ds_read_b128 v[104:107], v10
    v_mfma_f32_32x32x16_bf16 v[32:47], v[108:111], v[96:99], v[32:47]
    ds_read_b64_tr_b16 v[140:141], v13 offset:2048
    ds_read_b64_tr_b16 v[142:143], v13 offset:2560
    v_mfma_f32_32x32x16_bf16 v[48:63], v[112:115], v[96:99], v[48:63]
    ds_read_b64_tr_b16 v[144:145], v14 offset:2048
    ds_read_b64_tr_b16 v[146:147], v14 offset:2560
    ds_read_b64_tr_b16 v[148:149], v13 offset:10240
    v_mfma_f32_32x32x16_bf16 v[64:79], v[116:119], v[96:99], v[64:79]
    ds_read_b64_tr_b16 v[150:151], v13 offset:10752
    ds_read_b64_tr_b16 v[152:153], v14 offset:10240
    v_mfma_f32_32x32x16_bf16 v[80:95], v[120:123], v[96:99], v[80:95]
    ds_read_b64_tr_b16 v[154:155], v14 offset:10752
    ds_read_b128 v[96:99], v11
    v_mfma_f32_32x32x16_bf16 v[32:47], v[124:127], v[100:103], v[32:47]
    ds_read_b64_tr_b16 v[108:109], v13 offset:4096
    ds_read_b64_tr_b16 v[110:111], v13 offset:4608
    v_mfma_f32_32x32x16_bf16 v[48:63], v[128:131], v[100:103], v[48:63]
    ds_read_b64_tr_b16 v[112:113], v14 offset:4096
    ds_read_b64_tr_b16 v[114:115], v14 offset:4608
    ds_read_b64_tr_b16 v[116:117], v13 offset:12288
    v_mfma_f32_32x32x16_bf16 v[64:79], v[132:135], v[100:103], v[64:79]
    ds_read_b64_tr_b16 v[118:119], v13 offset:12800
    ds_read_b64_tr_b16 v[120:121], v14 offset:12288
    v_mfma_f32_32x32x16_bf16 v[80:95], v[136:139], v[100:103], v[80:95]
    ds_read_b64_tr_b16 v[122:123], v14 offset:12800
    v_mfma_f32_32x32x16_bf16 v[32:47], v[140:143], v[104:107], v[32:47]
    ds_read_b128 v[100:103], v12
    ds_read_b64_tr_b16 v[124:125], v13 offset:6144
    ds_read_b64_tr_b16 v[126:127], v13 offset:6656
    ds_read_b64_tr_b16 v[128:129], v14 offset:6144
    ds_read_b64_tr_b16 v[130:131], v14 offset:6656
    v_mfma_f32_32x32x16_bf16 v[48:63], v[144:147], v[104:107], v[48:63]
    ds_read_b64_tr_b16 v[132:133], v13 offset:14336
    ds_read_b64_tr_b16 v[134:135], v13 offset:14848
    ds_read_b64_tr_b16 v[136:137], v14 offset:14336
    ds_read_b64_tr_b16 v[138:139], v14 offset:14848
    v_mfma_f32_32x32x16_bf16 v[64:79], v[148:151], v[104:107], v[64:79]
    v_mfma_f32_32x32x16_bf16 v[80:95], v[152:155], v[104:107], v[80:95]
    s_waitcnt lgkmcnt(0)
    s_barrier
    v_add_u32 v9, 0x8000, v9
    v_add_u32 v10, 0x8000, v10
    v_add_u32 v11, 0x8000, v11
    v_add_u32 v12, 0x8000, v12
    v_add_u32 v13, 0x8000, v13
    v_add_u32 v14, 0x8000, v14
    ds_read_b128 v[104:107], v9
    v_mfma_f32_32x32x16_bf16 v[32:47], v[108:111], v[96:99], v[32:47]
    ds_read_b64_tr_b16 v[140:141], v13 offset:0
    ds_read_b64_tr_b16 v[142:143], v13 offset:512
    v_mfma_f32_32x32x16_bf16 v[48:63], v[112:115], v[96:99], v[48:63]
    ds_read_b64_tr_b16 v[144:145], v14 offset:0
    ds_read_b64_tr_b16 v[146:147], v14 offset:512
    ds_read_b64_tr_b16 v[148:149], v13 offset:8192
    v_mfma_f32_32x32x16_bf16 v[64:79], v[116:119], v[96:99], v[64:79]
    ds_read_b64_tr_b16 v[150:151], v13 offset:8704
    ds_read_b64_tr_b16 v[152:153], v14 offset:8192
    v_mfma_f32_32x32x16_bf16 v[80:95], v[120:123], v[96:99], v[80:95]
    ds_read_b64_tr_b16 v[154:155], v14 offset:8704
    ds_read_b128 v[96:99], v10
    v_mfma_f32_32x32x16_bf16 v[32:47], v[124:127], v[100:103], v[32:47]
    ds_read_b64_tr_b16 v[108:109], v13 offset:2048
    ds_read_b64_tr_b16 v[110:111], v13 offset:2560
    v_mfma_f32_32x32x16_bf16 v[48:63], v[128:131], v[100:103], v[48:63]
    ds_read_b64_tr_b16 v[112:113], v14 offset:2048
    ds_read_b64_tr_b16 v[114:115], v14 offset:2560
    ds_read_b64_tr_b16 v[116:117], v13 offset:10240
    v_mfma_f32_32x32x16_bf16 v[64:79], v[132:135], v[100:103], v[64:79]
    ds_read_b64_tr_b16 v[118:119], v13 offset:10752
    ds_read_b64_tr_b16 v[120:121], v14 offset:10240
    v_mfma_f32_32x32x16_bf16 v[80:95], v[136:139], v[100:103], v[80:95]
    ds_read_b64_tr_b16 v[122:123], v14 offset:10752
    ds_read_b128 v[100:103], v11
    v_mfma_f32_32x32x16_bf16 v[32:47], v[140:143], v[104:107], v[32:47]
    ds_read_b64_tr_b16 v[124:125], v13 offset:4096
    ds_read_b64_tr_b16 v[126:127], v13 offset:4608
    v_mfma_f32_32x32x16_bf16 v[48:63], v[144:147], v[104:107], v[48:63]
    ds_read_b64_tr_b16 v[128:129], v14 offset:4096
    ds_read_b64_tr_b16 v[130:131], v14 offset:4608
    ds_read_b64_tr_b16 v[132:133], v13 offset:12288
    v_mfma_f32_32x32x16_bf16 v[64:79], v[148:151], v[104:107], v[64:79]
    ds_read_b64_tr_b16 v[134:135], v13 offset:12800
    ds_read_b64_tr_b16 v[136:137], v14 offset:12288
    v_mfma_f32_32x32x16_bf16 v[80:95], v[152:155], v[104:107], v[80:95]
    ds_read_b64_tr_b16 v[138:139], v14 offset:12800
    v_mfma_f32_32x32x16_bf16 v[32:47], v[108:111], v[96:99], v[32:47]
    ds_read_b128 v[104:107], v12
    ds_read_b64_tr_b16 v[140:141], v13 offset:6144
    ds_read_b64_tr_b16 v[142:143], v13 offset:6656
    ds_read_b64_tr_b16 v[144:145], v14 offset:6144
    ds_read_b64_tr_b16 v[146:147], v14 offset:6656
    v_mfma_f32_32x32x16_bf16 v[48:63], v[112:115], v[96:99], v[48:63]
    ds_read_b64_tr_b16 v[148:149], v13 offset:14336
    ds_read_b64_tr_b16 v[150:151], v13 offset:14848
    ds_read_b64_tr_b16 v[152:153], v14 offset:14336
    ds_read_b64_tr_b16 v[154:155], v14 offset:14848
    v_mfma_f32_32x32x16_bf16 v[64:79], v[116:119], v[96:99], v[64:79]
    v_mfma_f32_32x32x16_bf16 v[80:95], v[120:123], v[96:99], v[80:95]
    s_waitcnt lgkmcnt(0)
    s_barrier
    v_add_u32 v9, 0x8000, v9
    v_add_u32 v10, 0x8000, v10
    v_add_u32 v11, 0x8000, v11
    v_add_u32 v12, 0x8000, v12
    v_add_u32 v13, 0x8000, v13
    v_add_u32 v14, 0x8000, v14
    ds_read_b128 v[96:99], v9
    v_mfma_f32_32x32x16_bf16 v[32:47], v[124:127], v[100:103], v[32:47]
    ds_read_b64_tr_b16 v[108:109], v13 offset:0
    ds_read_b64_tr_b16 v[110:111], v13 offset:512
    v_mfma_f32_32x32x16_bf16 v[48:63], v[128:131], v[100:103], v[48:63]
    ds_read_b64_tr_b16 v[112:113], v14 offset:0
    ds_read_b64_tr_b16 v[114:115], v14 offset:512
    ds_read_b64_tr_b16 v[116:117], v13 offset:8192
    v_mfma_f32_32x32x16_bf16 v[64:79], v[132:135], v[100:103], v[64:79]
    ds_read_b64_tr_b16 v[118:119], v13 offset:8704
    ds_read_b64_tr_b16 v[120:121], v14 offset:8192
    v_mfma_f32_32x32x16_bf16 v[80:95], v[136:139], v[100:103], v[80:95]
    ds_read_b64_tr_b16 v[122:123], v14 offset:8704
    ds_read_b128 v[100:103], v10
    v_mfma_f32_32x32x16_bf16 v[32:47], v[140:143], v[104:107], v[32:47]
    ds_read_b64_tr_b16 v[124:125], v13 offset:2048
    ds_read_b64_tr_b16 v[126:127], v13 offset:2560
    v_mfma_f32_32x32x16_bf16 v[48:63], v[144:147], v[104:107], v[48:63]
    ds_read_b64_tr_b16 v[128:129], v14 offset:2048
    ds_read_b64_tr_b16 v[130:131], v14 offset:2560
    ds_read_b64_tr_b16 v[132:133], v13 offset:10240
    v_mfma_f32_32x32x16_bf16 v[64:79], v[148:151], v[104:107], v[64:79]
    ds_read_b64_tr_b16 v[134:135], v13 offset:10752
    ds_read_b64_tr_b16 v[136:137], v14 offset:10240
    v_mfma_f32_32x32x16_bf16 v[80:95], v[152:155], v[104:107], v[80:95]
    ds_read_b64_tr_b16 v[138:139], v14 offset:10752
    ds_read_b128 v[104:107], v11
    v_mfma_f32_32x32x16_bf16 v[32:47], v[108:111], v[96:99], v[32:47]
    ds_read_b64_tr_b16 v[140:141], v13 offset:4096
    ds_read_b64_tr_b16 v[142:143], v13 offset:4608
    v_mfma_f32_32x32x16_bf16 v[48:63], v[112:115], v[96:99], v[48:63]
    ds_read_b64_tr_b16 v[144:145], v14 offset:4096
    ds_read_b64_tr_b16 v[146:147], v14 offset:4608
    ds_read_b64_tr_b16 v[148:149], v13 offset:12288
    v_mfma_f32_32x32x16_bf16 v[64:79], v[116:119], v[96:99], v[64:79]
    ds_read_b64_tr_b16 v[150:151], v13 offset:12800
    ds_read_b64_tr_b16 v[152:153], v14 offset:12288
    v_mfma_f32_32x32x16_bf16 v[80:95], v[120:123], v[96:99], v[80:95]
    ds_read_b64_tr_b16 v[154:155], v14 offset:12800
    v_mfma_f32_32x32x16_bf16 v[32:47], v[124:127], v[100:103], v[32:47]
    ds_read_b128 v[96:99], v12
    ds_read_b64_tr_b16 v[108:109], v13 offset:6144
    ds_read_b64_tr_b16 v[110:111], v13 offset:6656
    ds_read_b64_tr_b16 v[112:113], v14 offset:6144
    ds_read_b64_tr_b16 v[114:115], v14 offset:6656
    v_mfma_f32_32x32x16_bf16 v[48:63], v[128:131], v[100:103], v[48:63]
    ds_read_b64_tr_b16 v[116:117], v13 offset:14336
    ds_read_b64_tr_b16 v[118:119], v13 offset:14848
    ds_read_b64_tr_b16 v[120:121], v14 offset:14336
    ds_read_b64_tr_b16 v[122:123], v14 offset:14848
    v_mfma_f32_32x32x16_bf16 v[64:79], v[132:135], v[100:103], v[64:79]
    v_mfma_f32_32x32x16_bf16 v[80:95], v[136:139], v[100:103], v[80:95]
    s_waitcnt lgkmcnt(0)
    s_barrier
    v_add_u32 v9, 0xfffe8000, v9
    v_add_u32 v10, 0xfffe8000, v10
    v_add_u32 v11, 0xfffe8000, v11
    v_add_u32 v12, 0xfffe8000, v12
    v_add_u32 v13, 0xfffe8000, v13
    v_add_u32 v14, 0xfffe8000, v14
    ds_read_b128 v[100:103], v9
    v_mfma_f32_32x32x16_bf16 v[32:47], v[140:143], v[104:107], v[32:47]
    ds_read_b64_tr_b16 v[124:125], v13 offset:0
    ds_read_b64_tr_b16 v[126:127], v13 offset:512
    v_mfma_f32_32x32x16_bf16 v[48:63], v[144:147], v[104:107], v[48:63]
    ds_read_b64_tr_b16 v[128:129], v14 offset:0
    ds_read_b64_tr_b16 v[130:131], v14 offset:512
    ds_read_b64_tr_b16 v[132:133], v13 offset:8192
    v_mfma_f32_32x32x16_bf16 v[64:79], v[148:151], v[104:107], v[64:79]
    ds_read_b64_tr_b16 v[134:135], v13 offset:8704
    ds_read_b64_tr_b16 v[136:137], v14 offset:8192
    v_mfma_f32_32x32x16_bf16 v[80:95], v[152:155], v[104:107], v[80:95]
    ds_read_b64_tr_b16 v[138:139], v14 offset:8704
    ds_read_b128 v[104:107], v10
    v_mfma_f32_32x32x16_bf16 v[32:47], v[108:111], v[96:99], v[32:47]
    ds_read_b64_tr_b16 v[140:141], v13 offset:2048
    ds_read_b64_tr_b16 v[142:143], v13 offset:2560
    v_mfma_f32_32x32x16_bf16 v[48:63], v[112:115], v[96:99], v[48:63]
    ds_read_b64_tr_b16 v[144:145], v14 offset:2048
    ds_read_b64_tr_b16 v[146:147], v14 offset:2560
    ds_read_b64_tr_b16 v[148:149], v13 offset:10240
    v_mfma_f32_32x32x16_bf16 v[64:79], v[116:119], v[96:99], v[64:79]
    ds_read_b64_tr_b16 v[150:151], v13 offset:10752
    ds_read_b64_tr_b16 v[152:153], v14 offset:10240
    v_mfma_f32_32x32x16_bf16 v[80:95], v[120:123], v[96:99], v[80:95]
    ds_read_b64_tr_b16 v[154:155], v14 offset:10752
    ds_read_b128 v[96:99], v11
    v_mfma_f32_32x32x16_bf16 v[32:47], v[124:127], v[100:103], v[32:47]
    ds_read_b64_tr_b16 v[108:109], v13 offset:4096
    ds_read_b64_tr_b16 v[110:111], v13 offset:4608
    v_mfma_f32_32x32x16_bf16 v[48:63], v[128:131], v[100:103], v[48:63]
    ds_read_b64_tr_b16 v[112:113], v14 offset:4096
    ds_read_b64_tr_b16 v[114:115], v14 offset:4608
    ds_read_b64_tr_b16 v[116:117], v13 offset:12288
    v_mfma_f32_32x32x16_bf16 v[64:79], v[132:135], v[100:103], v[64:79]
    ds_read_b64_tr_b16 v[118:119], v13 offset:12800
    ds_read_b64_tr_b16 v[120:121], v14 offset:12288
    v_mfma_f32_32x32x16_bf16 v[80:95], v[136:139], v[100:103], v[80:95]
    ds_read_b64_tr_b16 v[122:123], v14 offset:12800
    v_mfma_f32_32x32x16_bf16 v[32:47], v[140:143], v[104:107], v[32:47]
    ds_read_b128 v[100:103], v12
    ds_read_b64_tr_b16 v[124:125], v13 offset:6144
    ds_read_b64_tr_b16 v[126:127], v13 offset:6656
    ds_read_b64_tr_b16 v[128:129], v14 offset:6144
    ds_read_b64_tr_b16 v[130:131], v14 offset:6656
    v_mfma_f32_32x32x16_bf16 v[48:63], v[144:147], v[104:107], v[48:63]
    ds_read_b64_tr_b16 v[132:133], v13 offset:14336
    ds_read_b64_tr_b16 v[134:135], v13 offset:14848
    ds_read_b64_tr_b16 v[136:137], v14 offset:14336
    ds_read_b64_tr_b16 v[138:139], v14 offset:14848
    v_mfma_f32_32x32x16_bf16 v[64:79], v[148:151], v[104:107], v[64:79]
    v_mfma_f32_32x32x16_bf16 v[80:95], v[152:155], v[104:107], v[80:95]
    s_waitcnt lgkmcnt(0)
    s_barrier
    v_add_u32 v9, 0x8000, v9
    v_add_u32 v10, 0x8000, v10
    v_add_u32 v11, 0x8000, v11
    v_add_u32 v12, 0x8000, v12
    v_add_u32 v13, 0x8000, v13
    v_add_u32 v14, 0x8000, v14
    ds_read_b128 v[104:107], v9
    v_mfma_f32_32x32x16_bf16 v[32:47], v[108:111], v[96:99], v[32:47]
    ds_read_b64_tr_b16 v[140:141], v13 offset:0
    ds_read_b64_tr_b16 v[142:143], v13 offset:512
    v_mfma_f32_32x32x16_bf16 v[48:63], v[112:115], v[96:99], v[48:63]
    ds_read_b64_tr_b16 v[144:145], v14 offset:0
    ds_read_b64_tr_b16 v[146:147], v14 offset:512
    ds_read_b64_tr_b16 v[148:149], v13 offset:8192
    v_mfma_f32_32x32x16_bf16 v[64:79], v[116:119], v[96:99], v[64:79]
    ds_read_b64_tr_b16 v[150:151], v13 offset:8704
    ds_read_b64_tr_b16 v[152:153], v14 offset:8192
    v_mfma_f32_32x32x16_bf16 v[80:95], v[120:123], v[96:99], v[80:95]
    ds_read_b64_tr_b16 v[154:155], v14 offset:8704
    v_mov_b32 v16, 147456
    s_waitcnt vmcnt(0)
    ds_read_b32 v15, v16
    ds_read_b128 v[96:99], v10
    v_mfma_f32_32x32x16_bf16 v[32:47], v[124:127], v[100:103], v[32:47]
    ds_read_b64_tr_b16 v[108:109], v13 offset:2048
    ds_read_b64_tr_b16 v[110:111], v13 offset:2560
    v_mfma_f32_32x32x16_bf16 v[48:63], v[128:131], v[100:103], v[48:63]
    ds_read_b64_tr_b16 v[112:113], v14 offset:2048
    ds_read_b64_tr_b16 v[114:115], v14 offset:2560
    ds_read_b64_tr_b16 v[116:117], v13 offset:10240
    v_mfma_f32_32x32x16_bf16 v[64:79], v[132:135], v[100:103], v[64:79]
    ds_read_b64_tr_b16 v[118:119], v13 offset:10752
    ds_read_b64_tr_b16 v[120:121], v14 offset:10240
    v_mfma_f32_32x32x16_bf16 v[80:95], v[136:139], v[100:103], v[80:95]
    ds_read_b64_tr_b16 v[122:123], v14 offset:10752
    ds_read_b128 v[100:103], v11
    v_mfma_f32_32x32x16_bf16 v[32:47], v[140:143], v[104:107], v[32:47]
    ds_read_b64_tr_b16 v[124:125], v13 offset:4096
    ds_read_b64_tr_b16 v[126:127], v13 offset:4608
    v_mfma_f32_32x32x16_bf16 v[48:63], v[144:147], v[104:107], v[48:63]
    ds_read_b64_tr_b16 v[128:129], v14 offset:4096
    ds_read_b64_tr_b16 v[130:131], v14 offset:4608
    ds_read_b64_tr_b16 v[132:133], v13 offset:12288
    v_mfma_f32_32x32x16_bf16 v[64:79], v[148:151], v[104:107], v[64:79]
    ds_read_b64_tr_b16 v[134:135], v13 offset:12800
    ds_read_b64_tr_b16 v[136:137], v14 offset:12288
    v_mfma_f32_32x32x16_bf16 v[80:95], v[152:155], v[104:107], v[80:95]
    ds_read_b64_tr_b16 v[138:139], v14 offset:12800
    v_mfma_f32_32x32x16_bf16 v[32:47], v[108:111], v[96:99], v[32:47]
    ds_read_b128 v[104:107], v12
    ds_read_b64_tr_b16 v[140:141], v13 offset:6144
    ds_read_b64_tr_b16 v[142:143], v13 offset:6656
    ds_read_b64_tr_b16 v[144:145], v14 offset:6144
    ds_read_b64_tr_b16 v[146:147], v14 offset:6656
    v_mfma_f32_32x32x16_bf16 v[48:63], v[112:115], v[96:99], v[48:63]
    ds_read_b64_tr_b16 v[148:149], v13 offset:14336
    ds_read_b64_tr_b16 v[150:151], v13 offset:14848
    ds_read_b64_tr_b16 v[152:153], v14 offset:14336
    ds_read_b64_tr_b16 v[154:155], v14 offset:14848
    v_mfma_f32_32x32x16_bf16 v[64:79], v[116:119], v[96:99], v[64:79]
    v_mfma_f32_32x32x16_bf16 v[80:95], v[120:123], v[96:99], v[80:95]
    s_waitcnt lgkmcnt(0)
    s_barrier
    v_add_u32 v9, 0x8000, v9
    v_add_u32 v10, 0x8000, v10
    v_add_u32 v11, 0x8000, v11
    v_add_u32 v12, 0x8000, v12
    v_add_u32 v13, 0x8000, v13
    v_add_u32 v14, 0x8000, v14
    ds_read_b128 v[96:99], v9
    v_mfma_f32_32x32x16_bf16 v[32:47], v[124:127], v[100:103], v[32:47]
    ds_read_b64_tr_b16 v[108:109], v13 offset:0
    ds_read_b64_tr_b16 v[110:111], v13 offset:512
    v_mfma_f32_32x32x16_bf16 v[48:63], v[128:131], v[100:103], v[48:63]
    ds_read_b64_tr_b16 v[112:113], v14 offset:0
    ds_read_b64_tr_b16 v[114:115], v14 offset:512
    ds_read_b64_tr_b16 v[116:117], v13 offset:8192
    v_mfma_f32_32x32x16_bf16 v[64:79], v[132:135], v[100:103], v[64:79]
    ds_read_b64_tr_b16 v[118:119], v13 offset:8704
    ds_read_b64_tr_b16 v[120:121], v14 offset:8192
    v_mfma_f32_32x32x16_bf16 v[80:95], v[136:139], v[100:103], v[80:95]
    ds_read_b64_tr_b16 v[122:123], v14 offset:8704
    ds_read_b128 v[100:103], v10
    v_mfma_f32_32x32x16_bf16 v[32:47], v[140:143], v[104:107], v[32:47]
    ds_read_b64_tr_b16 v[124:125], v13 offset:2048
    ds_read_b64_tr_b16 v[126:127], v13 offset:2560
    v_mfma_f32_32x32x16_bf16 v[48:63], v[144:147], v[104:107], v[48:63]
    ds_read_b64_tr_b16 v[128:129], v14 offset:2048
    ds_read_b64_tr_b16 v[130:131], v14 offset:2560
    ds_read_b64_tr_b16 v[132:133], v13 offset:10240
    v_mfma_f32_32x32x16_bf16 v[64:79], v[148:151], v[104:107], v[64:79]
    ds_read_b64_tr_b16 v[134:135], v13 offset:10752
    ds_read_b64_tr_b16 v[136:137], v14 offset:10240
    v_mfma_f32_32x32x16_bf16 v[80:95], v[152:155], v[104:107], v[80:95]
    ds_read_b64_tr_b16 v[138:139], v14 offset:10752
    ds_read_b128 v[104:107], v11
    v_mfma_f32_32x32x16_bf16 v[32:47], v[108:111], v[96:99], v[32:47]
    ds_read_b64_tr_b16 v[140:141], v13 offset:4096
    ds_read_b64_tr_b16 v[142:143], v13 offset:4608
    v_mfma_f32_32x32x16_bf16 v[48:63], v[112:115], v[96:99], v[48:63]
    ds_read_b64_tr_b16 v[144:145], v14 offset:4096
    ds_read_b64_tr_b16 v[146:147], v14 offset:4608
    ds_read_b64_tr_b16 v[148:149], v13 offset:12288
    v_mfma_f32_32x32x16_bf16 v[64:79], v[116:119], v[96:99], v[64:79]
    ds_read_b64_tr_b16 v[150:151], v13 offset:12800
    ds_read_b64_tr_b16 v[152:153], v14 offset:12288
    v_mfma_f32_32x32x16_bf16 v[80:95], v[120:123], v[96:99], v[80:95]
    ds_read_b64_tr_b16 v[154:155], v14 offset:12800
    buffer_load_dwordx4 v[156:159], v164, s[4:7], 0 offen sc0 sc1
    buffer_load_dwordx2 v[160:161], v165, s[4:7], s38 offen sc0 sc1
    buffer_load_dwordx2 v[162:163], v165, s[4:7], s39 offen sc0 sc1
    v_mfma_f32_32x32x16_bf16 v[32:47], v[124:127], v[100:103], v[32:47]
    ds_read_b128 v[96:99], v12
    ds_read_b64_tr_b16 v[108:109], v13 offset:6144
    ds_read_b64_tr_b16 v[110:111], v13 offset:6656
    ds_read_b64_tr_b16 v[112:113], v14 offset:6144
    ds_read_b64_tr_b16 v[114:115], v14 offset:6656
    v_mfma_f32_32x32x16_bf16 v[48:63], v[128:131], v[100:103], v[48:63]
    ds_read_b64_tr_b16 v[116:117], v13 offset:14336
    ds_read_b64_tr_b16 v[118:119], v13 offset:14848
    ds_read_b64_tr_b16 v[120:121], v14 offset:14336
    ds_read_b64_tr_b16 v[122:123], v14 offset:14848
    v_mfma_f32_32x32x16_bf16 v[64:79], v[132:135], v[100:103], v[64:79]
    v_mfma_f32_32x32x16_bf16 v[80:95], v[136:139], v[100:103], v[80:95]
    s_waitcnt lgkmcnt(0)
    s_barrier
    v_add_u32 v9, 0x8000, v9
    v_add_u32 v10, 0x8000, v10
    v_add_u32 v11, 0x8000, v11
    v_add_u32 v12, 0x8000, v12
    v_add_u32 v13, 0x8000, v13
    v_add_u32 v14, 0x8000, v14
    ds_read_b128 v[100:103], v9
    v_mfma_f32_32x32x16_bf16 v[32:47], v[140:143], v[104:107], v[32:47]
    ds_read_b64_tr_b16 v[124:125], v13 offset:0
    ds_read_b64_tr_b16 v[126:127], v13 offset:512
    v_mfma_f32_32x32x16_bf16 v[48:63], v[144:147], v[104:107], v[48:63]
    ds_read_b64_tr_b16 v[128:129], v14 offset:0
    ds_read_b64_tr_b16 v[130:131], v14 offset:512
    ds_read_b64_tr_b16 v[132:133], v13 offset:8192
    v_mfma_f32_32x32x16_bf16 v[64:79], v[148:151], v[104:107], v[64:79]
    ds_read_b64_tr_b16 v[134:135], v13 offset:8704
    ds_read_b64_tr_b16 v[136:137], v14 offset:8192
    v_mfma_f32_32x32x16_bf16 v[80:95], v[152:155], v[104:107], v[80:95]
    ds_read_b64_tr_b16 v[138:139], v14 offset:8704
    ds_read_b128 v[104:107], v10
    v_mfma_f32_32x32x16_bf16 v[32:47], v[108:111], v[96:99], v[32:47]
    ds_read_b64_tr_b16 v[140:141], v13 offset:2048
    ds_read_b64_tr_b16 v[142:143], v13 offset:2560
    v_mfma_f32_32x32x16_bf16 v[48:63], v[112:115], v[96:99], v[48:63]
    ds_read_b64_tr_b16 v[144:145], v14 offset:2048
    ds_read_b64_tr_b16 v[146:147], v14 offset:2560
    ds_read_b64_tr_b16 v[148:149], v13 offset:10240
    v_mfma_f32_32x32x16_bf16 v[64:79], v[116:119], v[96:99], v[64:79]
    ds_read_b64_tr_b16 v[150:151], v13 offset:10752
    ds_read_b64_tr_b16 v[152:153], v14 offset:10240
    v_mfma_f32_32x32x16_bf16 v[80:95], v[120:123], v[96:99], v[80:95]
    ds_read_b64_tr_b16 v[154:155], v14 offset:10752
    ds_read_b128 v[96:99], v11
    v_mfma_f32_32x32x16_bf16 v[32:47], v[124:127], v[100:103], v[32:47]
    ds_read_b64_tr_b16 v[108:109], v13 offset:4096
    ds_read_b64_tr_b16 v[110:111], v13 offset:4608
    v_mfma_f32_32x32x16_bf16 v[48:63], v[128:131], v[100:103], v[48:63]
    ds_read_b64_tr_b16 v[112:113], v14 offset:4096
    ds_read_b64_tr_b16 v[114:115], v14 offset:4608
    ds_read_b64_tr_b16 v[116:117], v13 offset:12288
    v_mfma_f32_32x32x16_bf16 v[64:79], v[132:135], v[100:103], v[64:79]
    ds_read_b64_tr_b16 v[118:119], v13 offset:12800
    ds_read_b64_tr_b16 v[120:121], v14 offset:12288
    v_mfma_f32_32x32x16_bf16 v[80:95], v[136:139], v[100:103], v[80:95]
    ds_read_b64_tr_b16 v[122:123], v14 offset:12800
    v_mfma_f32_32x32x16_bf16 v[32:47], v[140:143], v[104:107], v[32:47]
    ds_read_b128 v[100:103], v12
    ds_read_b64_tr_b16 v[124:125], v13 offset:6144
    ds_read_b64_tr_b16 v[126:127], v13 offset:6656
    ds_read_b64_tr_b16 v[128:129], v14 offset:6144
    ds_read_b64_tr_b16 v[130:131], v14 offset:6656
    v_mfma_f32_32x32x16_bf16 v[48:63], v[144:147], v[104:107], v[48:63]
    ds_read_b64_tr_b16 v[132:133], v13 offset:14336
    ds_read_b64_tr_b16 v[134:135], v13 offset:14848
    ds_read_b64_tr_b16 v[136:137], v14 offset:14336
    ds_read_b64_tr_b16 v[138:139], v14 offset:14848
    v_mfma_f32_32x32x16_bf16 v[64:79], v[148:151], v[104:107], v[64:79]
    v_mfma_f32_32x32x16_bf16 v[80:95], v[152:155], v[104:107], v[80:95]
    v_mfma_f32_32x32x16_bf16 v[32:47], v[108:111], v[96:99], v[32:47]
    s_waitcnt lgkmcnt(13)
    v_mfma_f32_32x32x16_bf16 v[48:63], v[112:115], v[96:99], v[48:63]
    s_waitcnt lgkmcnt(11)
    v_mfma_f32_32x32x16_bf16 v[64:79], v[116:119], v[96:99], v[64:79]
    s_waitcnt lgkmcnt(9)
    v_mfma_f32_32x32x16_bf16 v[80:95], v[120:123], v[96:99], v[80:95]
    s_waitcnt lgkmcnt(6)
    v_mfma_f32_32x32x16_bf16 v[32:47], v[124:127], v[100:103], v[32:47]
    s_waitcnt lgkmcnt(4)
    v_mfma_f32_32x32x16_bf16 v[48:63], v[128:131], v[100:103], v[48:63]
    s_waitcnt lgkmcnt(2)
    v_mfma_f32_32x32x16_bf16 v[64:79], v[132:135], v[100:103], v[64:79]
    s_waitcnt lgkmcnt(0)
    v_mfma_f32_32x32x16_bf16 v[80:95], v[136:139], v[100:103], v[80:95]
    s_cmp_eq_u32 s25, 0
    s_cbranch_scc0 k1_q
    s_barrier
    s_waitcnt vmcnt(1)
    v_xor_b32 v16, v161, v15
    s_waitcnt vmcnt(0)
    v_xor_b32 v17, v163, v15
    v_or_b32 v16, v16, v17
    v_xor_b32 v17, v157, v15
    v_or_b32 v16, v16, v17
    v_xor_b32 v17, v159, v15
    v_or_b32 v16, v16, v17
    v_cmp_ne_u32 vcc, 0, v16
    s_nop 0
    s_cmp_eq_u64 vcc, 0
    s_cbranch_scc1 fz_kernel_g1ok7
fz_kernel_g16:
    s_sleep 2
    buffer_load_dwordx4 v[156:159], v164, s[4:7], 0 offen sc0 sc1
    buffer_load_dwordx2 v[160:161], v165, s[4:7], s38 offen sc0 sc1
    buffer_load_dwordx2 v[162:163], v165, s[4:7], s39 offen sc0 sc1
    s_waitcnt vmcnt(1)
    v_xor_b32 v16, v161, v15
    s_waitcnt vmcnt(0)
    v_xor_b32 v17, v163, v15
    v_or_b32 v16, v16, v17
    v_xor_b32 v17, v157, v15
    v_or_b32 v16, v16, v17
    v_xor_b32 v17, v159, v15
    v_or_b32 v16, v16, v17
    v_cmp_ne_u32 vcc, 0, v16
    s_nop 0
    s_cmp_eq_u64 vcc, 0
    s_cbranch_scc1 fz_kernel_g1ok7
    s_sub_u32 s61, s61, 1
    s_cbranch_scc0 fz_kernel_g16
    s_mov_b32 s61, 0
fz_kernel_g1ok7:
    ds_write_b32 v20, v160
    ds_write_b32 v20, v162 offset:256
    s_waitcnt lgkmcnt(0)
    s_mov_b32 s50, 0xbdd2d3e8
    ds_read_b128 v[108:111], v22 offset:0
    ds_read_b128 v[112:115], v22 offset:16
    ds_read_b128 v[116:119], v22 offset:64
    ds_read_b128 v[120:123], v22 offset:80
    ds_read_b128 v[124:127], v22 offset:128
    ds_read_b128 v[128:131], v22 offset:144
    ds_read_b128 v[132:135], v22 offset:192
    ds_read_b128 v[136:139], v22 offset:208
    v_mul_f32 v32, v32, v156
    v_mul_f32 v33, v33, v156
    v_mul_f32 v34, v34, v156
    v_mul_f32 v35, v35, v156
    v_mul_f32 v36, v36, v156
    v_mul_f32 v37, v37, v156
    v_mul_f32 v38, v38, v156
    v_mul_f32 v39, v39, v156
    v_mul_f32 v40, v40, v156
    v_mul_f32 v41, v41, v156
    v_mul_f32 v42, v42, v156
    v_mul_f32 v43, v43, v156
    v_mul_f32 v44, v44, v156
    v_mul_f32 v45, v45, v156
    v_mul_f32 v46, v46, v156
    v_mul_f32 v47, v47, v156
    v_mul_f32 v48, v48, v156
    v_mul_f32 v49, v49, v156
    v_mul_f32 v50, v50, v156
    v_mul_f32 v51, v51, v156
    v_mul_f32 v52, v52, v156
    v_mul_f32 v53, v53, v156
    v_mul_f32 v54, v54, v156
    v_mul_f32 v55, v55, v156
    v_mul_f32 v56, v56, v156
    v_mul_f32 v57, v57, v156
    v_mul_f32 v58, v58, v156
    v_mul_f32 v59, v59, v156
    v_mul_f32 v60, v60, v156
    v_mul_f32 v61, v61, v156
    v_mul_f32 v62, v62, v156
    v_mul_f32 v63, v63, v156
    s_waitcnt lgkmcnt(7)
    v_fma_f32 v32, -v158, v108, v32
    v_fma_f32 v33, -v158, v109, v33
    v_fma_f32 v34, -v158, v110, v34
    v_fma_f32 v35, -v158, v111, v35
    s_waitcnt lgkmcnt(6)
    v_fma_f32 v36, -v158, v112, v36
    v_fma_f32 v37, -v158, v113, v37
    v_fma_f32 v38, -v158, v114, v38
    v_fma_f32 v39, -v158, v115, v39
    s_waitcnt lgkmcnt(5)
    v_fma_f32 v40, -v158, v116, v40
    v_fma_f32 v41, -v158, v117, v41
    v_fma_f32 v42, -v158, v118, v42
    v_fma_f32 v43, -v158, v119, v43
    s_waitcnt lgkmcnt(4)
    v_fma_f32 v44, -v158, v120, v44
    v_fma_f32 v45, -v158, v121, v45
    v_fma_f32 v46, -v158, v122, v46
    v_fma_f32 v47, -v158, v123, v47
    s_waitcnt lgkmcnt(3)
    v_fma_f32 v48, -v158, v124, v48
    v_fma_f32 v49, -v158, v125, v49
    v_fma_f32 v50, -v158, v126, v50
    v_fma_f32 v51, -v158, v127, v51
    s_waitcnt lgkmcnt(2)
    v_fma_f32 v52, -v158, v128, v52
    v_fma_f32 v53, -v158, v129, v53
    v_fma_f32 v54, -v158, v130, v54
    v_fma_f32 v55, -v158, v131, v55
    s_waitcnt lgkmcnt(1)
    v_fma_f32 v56, -v158, v132, v56
    v_fma_f32 v57, -v158, v133, v57
    v_fma_f32 v58, -v158, v134, v58
    v_fma_f32 v59, -v158, v135, v59
    s_waitcnt lgkmcnt(0)
    v_fma_f32 v60, -v158, v136, v60
    v_fma_f32 v61, -v158, v137, v61
    v_fma_f32 v62, -v158, v138, v62
    v_fma_f32 v63, -v158, v139, v63
    v_mul_f32 v108, v32, v32
    v_mul_f32 v109, v33, v33
    v_mul_f32 v110, v34, v34
    v_mul_f32 v111, v35, v35
    v_mul_f32 v112, v36, v36
    v_mul_f32 v113, v37, v37
    v_mul_f32 v114, v38, v38
    v_mul_f32 v115, v39, v39
    v_mul_f32 v116, v40, v40
    v_mul_f32 v117, v41, v41
    v_mul_f32 v118, v42, v42
    v_mul_f32 v119, v43, v43
    v_mul_f32 v120, v44, v44
    v_mul_f32 v121, v45, v45
    v_mul_f32 v122, v46, v46
    v_mul_f32 v123, v47, v47
    v_fma_f32 v108, v108, s50, v3
    v_fma_f32 v109, v109, s50, v3
    v_fma_f32 v110, v110, s50, v3
    v_fma_f32 v111, v111, s50, v3
    v_fma_f32 v112, v112, s50, v3
    v_fma_f32 v113, v113, s50, v3
    v_fma_f32 v114, v114, s50, v3
    v_fma_f32 v115, v115, s50, v3
    v_fma_f32 v116, v116, s50, v3
    v_fma_f32 v117, v117, s50, v3
    v_fma_f32 v118, v118, s50, v3
    v_fma_f32 v119, v119, s50, v3
    v_fma_f32 v120, v120, s50, v3
    v_fma_f32 v121, v121, s50, v3
    v_fma_f32 v122, v122, s50, v3
    v_fma_f32 v123, v123, s50, v3
    v_mul_f32 v108, v108, v32
    v_mul_f32 v109, v109, v33
    v_mul_f32 v110, v110, v34
    v_mul_f32 v111, v111, v35
    v_mul_f32 v112, v112, v36
    s_barrier
    v_mul_f32 v113, v113, v37
    v_mul_f32 v114, v114, v38
    v_mul_f32 v115, v115, v39
    v_mul_f32 v116, v116, v40
    v_mul_f32 v117, v117, v41
    v_mul_f32 v118, v118, v42
    v_mul_f32 v119, v119, v43
    v_mul_f32 v120, v120, v44
    v_mul_f32 v121, v121, v45
    v_mul_f32 v122, v122, v46
    v_mul_f32 v123, v123, v47
    v_exp_f32 v108, v108
    v_exp_f32 v109, v109
    v_exp_f32 v110, v110
    v_exp_f32 v111, v111
    v_exp_f32 v112, v112
    v_exp_f32 v113, v113
    v_exp_f32 v114, v114
    v_exp_f32 v115, v115
    v_exp_f32 v116, v116
    v_exp_f32 v117, v117
    v_exp_f32 v118, v118
    v_exp_f32 v119, v119
    v_exp_f32 v120, v120
    v_exp_f32 v121, v121
    v_exp_f32 v122, v122
    v_exp_f32 v123, v123
    v_add_f32 v108, 1.0, v108
    v_add_f32 v109, 1.0, v109
    v_add_f32 v110, 1.0, v110
    v_add_f32 v111, 1.0, v111
    v_add_f32 v112, 1.0, v112
    v_add_f32 v113, 1.0, v113
    v_add_f32 v114, 1.0, v114
    v_add_f32 v115, 1.0, v115
    v_add_f32 v116, 1.0, v116
    v_add_f32 v117, 1.0, v117
    v_add_f32 v118, 1.0, v118
    v_add_f32 v119, 1.0, v119
    v_add_f32 v120, 1.0, v120
    v_add_f32 v121, 1.0, v121
    v_add_f32 v122, 1.0, v122
    v_add_f32 v123, 1.0, v123
    v_rcp_f32 v108, v108
    v_rcp_f32 v109, v109
    v_rcp_f32 v110, v110
    v_rcp_f32 v111, v111
    v_rcp_f32 v112, v112
    v_rcp_f32 v113, v113
    v_rcp_f32 v114, v114
    v_rcp_f32 v115, v115
    v_rcp_f32 v116, v116
    v_rcp_f32 v117, v117
    v_rcp_f32 v118, v118
    v_rcp_f32 v119, v119
    v_rcp_f32 v120, v120
    v_rcp_f32 v121, v121
    v_rcp_f32 v122, v122
    v_rcp_f32 v123, v123
    v_mul_f32 v32, v32, v108
    v_mul_f32 v33, v33, v109
    v_mul_f32 v34, v34, v110
    v_mul_f32 v35, v35, v111
    v_mul_f32 v36, v36, v112
    v_mul_f32 v37, v37, v113
    v_mul_f32 v38, v38, v114
    v_mul_f32 v39, v39, v115
    v_mul_f32 v40, v40, v116
    v_mul_f32 v41, v41, v117
    v_mul_f32 v42, v42, v118
    v_mul_f32 v43, v43, v119
    v_mul_f32 v44, v44, v120
    v_mul_f32 v45, v45, v121
    v_mul_f32 v46, v46, v122
    v_mul_f32 v47, v47, v123
    v_mul_f32 v108, v48, v48
    v_mul_f32 v109, v49, v49
    v_mul_f32 v110, v50, v50
    v_mul_f32 v111, v51, v51
    v_mul_f32 v112, v52, v52
    v_mul_f32 v113, v53, v53
    v_mul_f32 v114, v54, v54
    v_mul_f32 v115, v55, v55
    v_mul_f32 v116, v56, v56
    v_mul_f32 v117, v57, v57
    v_mul_f32 v118, v58, v58
    v_mul_f32 v119, v59, v59
    v_mul_f32 v120, v60, v60
    v_mul_f32 v121, v61, v61
    v_mul_f32 v122, v62, v62
    v_mul_f32 v123, v63, v63
    v_fma_f32 v108, v108, s50, v3
    v_fma_f32 v109, v109, s50, v3
    v_fma_f32 v110, v110, s50, v3
    v_fma_f32 v111, v111, s50, v3
    v_fma_f32 v112, v112, s50, v3
    v_fma_f32 v113, v113, s50, v3
    v_fma_f32 v114, v114, s50, v3
    v_fma_f32 v115, v115, s50, v3
    v_fma_f32 v116, v116, s50, v3
    v_fma_f32 v117, v117, s50, v3
    v_fma_f32 v118, v118, s50, v3
    v_fma_f32 v119, v119, s50, v3
    v_fma_f32 v120, v120, s50, v3
    v_fma_f32 v121, v121, s50, v3
    v_fma_f32 v122, v122, s50, v3
    v_fma_f32 v123, v123, s50, v3
    v_mul_f32 v108, v108, v48
    v_mul_f32 v109, v109, v49
    v_mul_f32 v110, v110, v50
    v_mul_f32 v111, v111, v51
    v_mul_f32 v112, v112, v52
    v_mul_f32 v113, v113, v53
    v_mul_f32 v114, v114, v54
    v_mul_f32 v115, v115, v55
    v_mul_f32 v116, v116, v56
    v_mul_f32 v117, v117, v57
    v_mul_f32 v118, v118, v58
    v_mul_f32 v119, v119, v59
    v_mul_f32 v120, v120, v60
    v_mul_f32 v121, v121, v61
    v_mul_f32 v122, v122, v62
    v_mul_f32 v123, v123, v63
    v_exp_f32 v108, v108
    v_exp_f32 v109, v109
    v_exp_f32 v110, v110
    v_exp_f32 v111, v111
    v_exp_f32 v112, v112
    v_exp_f32 v113, v113
    v_exp_f32 v114, v114
    v_exp_f32 v115, v115
    v_exp_f32 v116, v116
    v_exp_f32 v117, v117
    v_exp_f32 v118, v118
    v_exp_f32 v119, v119
    v_exp_f32 v120, v120
    v_exp_f32 v121, v121
    v_exp_f32 v122, v122
    v_exp_f32 v123, v123
    v_add_f32 v108, 1.0, v108
    v_add_f32 v109, 1.0, v109
    v_add_f32 v110, 1.0, v110
    v_add_f32 v111, 1.0, v111
    v_add_f32 v112, 1.0, v112
    v_add_f32 v113, 1.0, v113
    v_add_f32 v114, 1.0, v114
    v_add_f32 v115, 1.0, v115
    s_barrier
    v_add_f32 v116, 1.0, v116
    v_add_f32 v117, 1.0, v117
    v_add_f32 v118, 1.0, v118
    v_add_f32 v119, 1.0, v119
    v_add_f32 v120, 1.0, v120
    v_add_f32 v121, 1.0, v121
    v_add_f32 v122, 1.0, v122
    v_add_f32 v123, 1.0, v123
    v_rcp_f32 v108, v108
    v_rcp_f32 v109, v109
    v_rcp_f32 v110, v110
    v_rcp_f32 v111, v111
    v_rcp_f32 v112, v112
    v_rcp_f32 v113, v113
    v_rcp_f32 v114, v114
    v_rcp_f32 v115, v115
    v_rcp_f32 v116, v116
    v_rcp_f32 v117, v117
    v_rcp_f32 v118, v118
    v_rcp_f32 v119, v119
    v_rcp_f32 v120, v120
    v_rcp_f32 v121, v121
    v_rcp_f32 v122, v122
    v_rcp_f32 v123, v123
    v_mul_f32 v48, v48, v108
    v_mul_f32 v49, v49, v109
    v_mul_f32 v50, v50, v110
    v_mul_f32 v51, v51, v111
    v_mul_f32 v52, v52, v112
    v_mul_f32 v53, v53, v113
    v_mul_f32 v54, v54, v114
    v_mul_f32 v55, v55, v115
    v_mul_f32 v56, v56, v116
    v_mul_f32 v57, v57, v117
    v_mul_f32 v58, v58, v118
    v_mul_f32 v59, v59, v119
    v_mul_f32 v60, v60, v120
    v_mul_f32 v61, v61, v121
    v_mul_f32 v62, v62, v122
    v_mul_f32 v63, v63, v123
    v_add_f32 v96, v32, v33
    v_mul_f32 v98, v32, v32
    v_add_f32 v97, v34, v35
    v_mul_f32 v99, v33, v33
    v_fmac_f32 v98, v34, v34
    v_fmac_f32 v99, v35, v35
    v_add_f32 v96, v96, v36
    v_fmac_f32 v98, v36, v36
    v_add_f32 v97, v97, v37
    v_fmac_f32 v99, v37, v37
    v_add_f32 v96, v96, v38
    v_fmac_f32 v98, v38, v38
    v_add_f32 v97, v97, v39
    v_fmac_f32 v99, v39, v39
    v_add_f32 v96, v96, v40
    v_fmac_f32 v98, v40, v40
    v_add_f32 v97, v97, v41
    v_fmac_f32 v99, v41, v41
    v_add_f32 v96, v96, v42
    v_fmac_f32 v98, v42, v42
    v_add_f32 v97, v97, v43
    v_fmac_f32 v99, v43, v43
    v_add_f32 v96, v96, v44
    v_fmac_f32 v98, v44, v44
    v_add_f32 v97, v97, v45
    v_fmac_f32 v99, v45, v45
    v_add_f32 v96, v96, v46
    v_fmac_f32 v98, v46, v46
    v_add_f32 v97, v97, v47
    v_fmac_f32 v99, v47, v47
    v_add_f32 v96, v96, v48
    v_fmac_f32 v98, v48, v48
    v_add_f32 v97, v97, v49
    v_fmac_f32 v99, v49, v49
    v_add_f32 v96, v96, v50
    v_fmac_f32 v98, v50, v50
    v_add_f32 v97, v97, v51
    v_fmac_f32 v99, v51, v51
    v_add_f32 v96, v96, v52
    v_fmac_f32 v98, v52, v52
    v_add_f32 v97, v97, v53
    v_fmac_f32 v99, v53, v53
    v_add_f32 v96, v96, v54
    v_fmac_f32 v98, v54, v54
    v_add_f32 v97, v97, v55
    v_fmac_f32 v99, v55, v55
    v_add_f32 v96, v96, v56
    v_fmac_f32 v98, v56, v56
    v_add_f32 v97, v97, v57
    v_fmac_f32 v99, v57, v57
    v_add_f32 v96, v96, v58
    v_fmac_f32 v98, v58, v58
    v_add_f32 v97, v97, v59
    v_fmac_f32 v99, v59, v59
    v_add_f32 v96, v96, v60
    v_fmac_f32 v98, v60, v60
    v_add_f32 v97, v97, v61
    v_fmac_f32 v99, v61, v61
    v_add_f32 v96, v96, v62
    v_fmac_f32 v98, v62, v62
    v_add_f32 v97, v97, v63
    v_fmac_f32 v99, v63, v63
    v_add_f32 v96, v96, v97
    v_add_f32 v98, v98, v99
    s_nop 1
    v_permlane32_swap_b32 v96, v98
    v_add_f32 v96, v96, v98
    v_mov_b32 v97, v15
    s_mul_i32 s44, s36, 7168
    s_add_u32 s44, s44, 22020096
    s_lshl_b32 s41, s27, 9
    s_add_u32 s41, s41, s44
    buffer_store_dwordx2 v[96:97], v21, s[4:7], s41 offen sc0 sc1
    ds_read_b128 v[108:111], v22 offset:256
    ds_read_b128 v[112:115], v22 offset:272
    ds_read_b128 v[116:119], v22 offset:320
    ds_read_b128 v[120:123], v22 offset:336
    ds_read_b128 v[124:127], v22 offset:384
    ds_read_b128 v[128:131], v22 offset:400
    ds_read_b128 v[132:135], v22 offset:448
    ds_read_b128 v[136:139], v22 offset:464
    v_mul_f32 v64, v64, v156
    v_mul_f32 v65, v65, v156
    v_mul_f32 v66, v66, v156
    v_mul_f32 v67, v67, v156
    v_mul_f32 v68, v68, v156
    v_mul_f32 v69, v69, v156
    v_mul_f32 v70, v70, v156
    v_mul_f32 v71, v71, v156
    v_mul_f32 v72, v72, v156
    v_mul_f32 v73, v73, v156
    v_mul_f32 v74, v74, v156
    v_mul_f32 v75, v75, v156
    v_mul_f32 v76, v76, v156
    v_mul_f32 v77, v77, v156
    v_mul_f32 v78, v78, v156
    v_mul_f32 v79, v79, v156
    v_mul_f32 v80, v80, v156
    v_mul_f32 v81, v81, v156
    v_mul_f32 v82, v82, v156
    v_mul_f32 v83, v83, v156
    v_mul_f32 v84, v84, v156
    v_mul_f32 v85, v85, v156
    v_mul_f32 v86, v86, v156
    v_mul_f32 v87, v87, v156
    v_mul_f32 v88, v88, v156
    v_mul_f32 v89, v89, v156
    v_mul_f32 v90, v90, v156
    v_mul_f32 v91, v91, v156
    s_barrier
    v_mul_f32 v92, v92, v156
    v_mul_f32 v93, v93, v156
    v_mul_f32 v94, v94, v156
    v_mul_f32 v95, v95, v156
    s_waitcnt lgkmcnt(7)
    v_fma_f32 v64, -v158, v108, v64
    v_fma_f32 v65, -v158, v109, v65
    v_fma_f32 v66, -v158, v110, v66
    v_fma_f32 v67, -v158, v111, v67
    s_waitcnt lgkmcnt(6)
    v_fma_f32 v68, -v158, v112, v68
    v_fma_f32 v69, -v158, v113, v69
    v_fma_f32 v70, -v158, v114, v70
    v_fma_f32 v71, -v158, v115, v71
    s_waitcnt lgkmcnt(5)
    v_fma_f32 v72, -v158, v116, v72
    v_fma_f32 v73, -v158, v117, v73
    v_fma_f32 v74, -v158, v118, v74
    v_fma_f32 v75, -v158, v119, v75
    s_waitcnt lgkmcnt(4)
    v_fma_f32 v76, -v158, v120, v76
    v_fma_f32 v77, -v158, v121, v77
    v_fma_f32 v78, -v158, v122, v78
    v_fma_f32 v79, -v158, v123, v79
    s_waitcnt lgkmcnt(3)
    v_fma_f32 v80, -v158, v124, v80
    v_fma_f32 v81, -v158, v125, v81
    v_fma_f32 v82, -v158, v126, v82
    v_fma_f32 v83, -v158, v127, v83
    s_waitcnt lgkmcnt(2)
    v_fma_f32 v84, -v158, v128, v84
    v_fma_f32 v85, -v158, v129, v85
    v_fma_f32 v86, -v158, v130, v86
    v_fma_f32 v87, -v158, v131, v87
    s_waitcnt lgkmcnt(1)
    v_fma_f32 v88, -v158, v132, v88
    v_fma_f32 v89, -v158, v133, v89
    v_fma_f32 v90, -v158, v134, v90
    v_fma_f32 v91, -v158, v135, v91
    s_waitcnt lgkmcnt(0)
    v_fma_f32 v92, -v158, v136, v92
    v_fma_f32 v93, -v158, v137, v93
    v_fma_f32 v94, -v158, v138, v94
    v_fma_f32 v95, -v158, v139, v95
    v_mul_f32 v108, v64, v64
    v_mul_f32 v109, v65, v65
    v_mul_f32 v110, v66, v66
    v_mul_f32 v111, v67, v67
    v_mul_f32 v112, v68, v68
    v_mul_f32 v113, v69, v69
    v_mul_f32 v114, v70, v70
    v_mul_f32 v115, v71, v71
    v_mul_f32 v116, v72, v72
    v_mul_f32 v117, v73, v73
    v_mul_f32 v118, v74, v74
    v_mul_f32 v119, v75, v75
    v_mul_f32 v120, v76, v76
    v_mul_f32 v121, v77, v77
    v_mul_f32 v122, v78, v78
    v_mul_f32 v123, v79, v79
    v_fma_f32 v108, v108, s50, v3
    v_fma_f32 v109, v109, s50, v3
    v_fma_f32 v110, v110, s50, v3
    v_fma_f32 v111, v111, s50, v3
    v_fma_f32 v112, v112, s50, v3
    v_fma_f32 v113, v113, s50, v3
    v_fma_f32 v114, v114, s50, v3
    v_fma_f32 v115, v115, s50, v3
    v_fma_f32 v116, v116, s50, v3
    v_fma_f32 v117, v117, s50, v3
    v_fma_f32 v118, v118, s50, v3
    v_fma_f32 v119, v119, s50, v3
    v_fma_f32 v120, v120, s50, v3
    v_fma_f32 v121, v121, s50, v3
    v_fma_f32 v122, v122, s50, v3
    v_fma_f32 v123, v123, s50, v3
    v_mul_f32 v108, v108, v64
    v_mul_f32 v109, v109, v65
    v_mul_f32 v110, v110, v66
    v_mul_f32 v111, v111, v67
    v_mul_f32 v112, v112, v68
    v_mul_f32 v113, v113, v69
    v_mul_f32 v114, v114, v70
    v_mul_f32 v115, v115, v71
    v_mul_f32 v116, v116, v72
    v_mul_f32 v117, v117, v73
    v_mul_f32 v118, v118, v74
    v_mul_f32 v119, v119, v75
    v_mul_f32 v120, v120, v76
    v_mul_f32 v121, v121, v77
    v_mul_f32 v122, v122, v78
    v_mul_f32 v123, v123, v79
    v_exp_f32 v108, v108
    v_exp_f32 v109, v109
    v_exp_f32 v110, v110
    v_exp_f32 v111, v111
    v_exp_f32 v112, v112
    v_exp_f32 v113, v113
    v_exp_f32 v114, v114
    v_exp_f32 v115, v115
    v_exp_f32 v116, v116
    v_exp_f32 v117, v117
    v_exp_f32 v118, v118
    v_exp_f32 v119, v119
    v_exp_f32 v120, v120
    v_exp_f32 v121, v121
    v_exp_f32 v122, v122
    v_exp_f32 v123, v123
    v_add_f32 v108, 1.0, v108
    v_add_f32 v109, 1.0, v109
    v_add_f32 v110, 1.0, v110
    v_add_f32 v111, 1.0, v111
    v_add_f32 v112, 1.0, v112
    v_add_f32 v113, 1.0, v113
    v_add_f32 v114, 1.0, v114
    v_add_f32 v115, 1.0, v115
    v_add_f32 v116, 1.0, v116
    v_add_f32 v117, 1.0, v117
    v_add_f32 v118, 1.0, v118
    v_add_f32 v119, 1.0, v119
    v_add_f32 v120, 1.0, v120
    v_add_f32 v121, 1.0, v121
    v_add_f32 v122, 1.0, v122
    v_add_f32 v123, 1.0, v123
    v_rcp_f32 v108, v108
    v_rcp_f32 v109, v109
    v_rcp_f32 v110, v110
    v_rcp_f32 v111, v111
    v_rcp_f32 v112, v112
    v_rcp_f32 v113, v113
    v_rcp_f32 v114, v114
    v_rcp_f32 v115, v115
    v_rcp_f32 v116, v116
    v_rcp_f32 v117, v117
    v_rcp_f32 v118, v118
    v_rcp_f32 v119, v119
    v_rcp_f32 v120, v120
    v_rcp_f32 v121, v121
    v_rcp_f32 v122, v122
    v_rcp_f32 v123, v123
    v_mul_f32 v64, v64, v108
    v_mul_f32 v65, v65, v109
    v_mul_f32 v66, v66, v110
    v_mul_f32 v67, v67, v111
    v_mul_f32 v68, v68, v112
    v_mul_f32 v69, v69, v113
    v_mul_f32 v70, v70, v114
    v_mul_f32 v71, v71, v115
    v_mul_f32 v72, v72, v116
    v_mul_f32 v73, v73, v117
    v_mul_f32 v74, v74, v118
    v_mul_f32 v75, v75, v119
    v_mul_f32 v76, v76, v120
    v_mul_f32 v77, v77, v121
    v_mul_f32 v78, v78, v122
    v_mul_f32 v79, v79, v123
    v_mul_f32 v108, v80, v80
    v_mul_f32 v109, v81, v81
    v_mul_f32 v110, v82, v82
    v_mul_f32 v111, v83, v83
    v_mul_f32 v112, v84, v84
    v_mul_f32 v113, v85, v85
    v_mul_f32 v114, v86, v86
    v_mul_f32 v115, v87, v87
    v_mul_f32 v116, v88, v88
    v_mul_f32 v117, v89, v89
    v_mul_f32 v118, v90, v90
    v_mul_f32 v119, v91, v91
    v_mul_f32 v120, v92, v92
    v_mul_f32 v121, v93, v93
    v_mul_f32 v122, v94, v94
    s_barrier
    v_mul_f32 v123, v95, v95
    v_fma_f32 v108, v108, s50, v3
    v_fma_f32 v109, v109, s50, v3
    v_fma_f32 v110, v110, s50, v3
    v_fma_f32 v111, v111, s50, v3
    v_fma_f32 v112, v112, s50, v3
    v_fma_f32 v113, v113, s50, v3
    v_fma_f32 v114, v114, s50, v3
    v_fma_f32 v115, v115, s50, v3
    v_fma_f32 v116, v116, s50, v3
    v_fma_f32 v117, v117, s50, v3
    v_fma_f32 v118, v118, s50, v3
    v_fma_f32 v119, v119, s50, v3
    v_fma_f32 v120, v120, s50, v3
    v_fma_f32 v121, v121, s50, v3
    v_fma_f32 v122, v122, s50, v3
    v_fma_f32 v123, v123, s50, v3
    v_mul_f32 v108, v108, v80
    v_mul_f32 v109, v109, v81
    v_mul_f32 v110, v110, v82
    v_mul_f32 v111, v111, v83
    v_mul_f32 v112, v112, v84
    v_mul_f32 v113, v113, v85
    v_mul_f32 v114, v114, v86
    v_mul_f32 v115, v115, v87
    v_mul_f32 v116, v116, v88
    v_mul_f32 v117, v117, v89
    v_mul_f32 v118, v118, v90
    v_mul_f32 v119, v119, v91
    v_mul_f32 v120, v120, v92
    v_mul_f32 v121, v121, v93
    v_mul_f32 v122, v122, v94
    v_mul_f32 v123, v123, v95
    v_exp_f32 v108, v108
    v_exp_f32 v109, v109
    v_exp_f32 v110, v110
    v_exp_f32 v111, v111
    v_exp_f32 v112, v112
    v_exp_f32 v113, v113
    v_exp_f32 v114, v114
    v_exp_f32 v115, v115
    v_exp_f32 v116, v116
    v_exp_f32 v117, v117
    v_exp_f32 v118, v118
    v_exp_f32 v119, v119
    v_exp_f32 v120, v120
    v_exp_f32 v121, v121
    v_exp_f32 v122, v122
    v_exp_f32 v123, v123
    v_add_f32 v108, 1.0, v108
    v_add_f32 v109, 1.0, v109
    v_add_f32 v110, 1.0, v110
    v_add_f32 v111, 1.0, v111
    v_add_f32 v112, 1.0, v112
    v_add_f32 v113, 1.0, v113
    v_add_f32 v114, 1.0, v114
    v_add_f32 v115, 1.0, v115
    v_add_f32 v116, 1.0, v116
    v_add_f32 v117, 1.0, v117
    v_add_f32 v118, 1.0, v118
    v_add_f32 v119, 1.0, v119
    v_add_f32 v120, 1.0, v120
    v_add_f32 v121, 1.0, v121
    v_add_f32 v122, 1.0, v122
    v_add_f32 v123, 1.0, v123
    v_rcp_f32 v108, v108
    v_rcp_f32 v109, v109
    v_rcp_f32 v110, v110
    v_rcp_f32 v111, v111
    v_rcp_f32 v112, v112
    v_rcp_f32 v113, v113
    v_rcp_f32 v114, v114
    v_rcp_f32 v115, v115
    v_rcp_f32 v116, v116
    v_rcp_f32 v117, v117
    v_rcp_f32 v118, v118
    v_rcp_f32 v119, v119
    v_rcp_f32 v120, v120
    v_rcp_f32 v121, v121
    v_rcp_f32 v122, v122
    v_rcp_f32 v123, v123
    v_mul_f32 v80, v80, v108
    v_mul_f32 v81, v81, v109
    v_mul_f32 v82, v82, v110
    v_mul_f32 v83, v83, v111
    v_mul_f32 v84, v84, v112
    v_mul_f32 v85, v85, v113
    v_mul_f32 v86, v86, v114
    v_mul_f32 v87, v87, v115
    v_mul_f32 v88, v88, v116
    v_mul_f32 v89, v89, v117
    v_mul_f32 v90, v90, v118
    v_mul_f32 v91, v91, v119
    v_mul_f32 v92, v92, v120
    v_mul_f32 v93, v93, v121
    v_mul_f32 v94, v94, v122
    v_mul_f32 v95, v95, v123
    s_add_u32 s40, s44, 0
    buffer_load_dwordx4 v[108:111], v2, s[4:7], s40 offen offset:0 sc0 sc1
    buffer_load_dwordx4 v[112:115], v2, s[4:7], s40 offen offset:1024 sc0 sc1
    buffer_load_dwordx4 v[116:119], v2, s[4:7], s40 offen offset:2048 sc0 sc1
    buffer_load_dwordx4 v[120:123], v2, s[4:7], s40 offen offset:3072 sc0 sc1
    s_add_u32 s40, s44, 4096
    buffer_load_dwordx4 v[124:127], v2, s[4:7], s40 offen offset:0 sc0 sc1
    buffer_load_dwordx4 v[128:131], v2, s[4:7], s40 offen offset:1024 sc0 sc1
    buffer_load_dwordx4 v[132:135], v2, s[4:7], s40 offen offset:2048 sc0 sc1
    v_cvt_pk_bf16_f32 v64, v64, v65
    v_cvt_pk_bf16_f32 v65, v66, v67
    v_cvt_pk_bf16_f32 v66, v68, v69
    v_cvt_pk_bf16_f32 v67, v70, v71
    v_cvt_pk_bf16_f32 v72, v72, v73
    v_cvt_pk_bf16_f32 v73, v74, v75
    v_cvt_pk_bf16_f32 v74, v76, v77
    v_cvt_pk_bf16_f32 v75, v78, v79
    v_cvt_pk_bf16_f32 v80, v80, v81
    v_cvt_pk_bf16_f32 v81, v82, v83
    v_cvt_pk_bf16_f32 v82, v84, v85
    v_cvt_pk_bf16_f32 v83, v86, v87
    v_cvt_pk_bf16_f32 v88, v88, v89
    v_cvt_pk_bf16_f32 v89, v90, v91
    v_cvt_pk_bf16_f32 v90, v92, v93
    v_cvt_pk_bf16_f32 v91, v94, v95
    s_mul_i32 s41, s36, 57344
    s_lshl_b32 s42, s27, 12
    s_add_u32 s41, s41, s42
    s_add_u32 s41, s41, 6291456
    buffer_store_dwordx4 v[64:67], v2, s[4:7], s41 offen offset:0 sc1
    buffer_store_dwordx4 v[72:75], v2, s[4:7], s41 offen offset:1024 sc1
    buffer_store_dwordx4 v[80:83], v2, s[4:7], s41 offen offset:2048 sc1
    buffer_store_dwordx4 v[88:91], v2, s[4:7], s41 offen offset:3072 sc1
    s_barrier
    s_waitcnt vmcnt(10)
    v_xor_b32 v16, v109, v15
    v_xor_b32 v17, v111, v15
    v_or_b32 v16, v16, v17
    s_waitcnt vmcnt(9)
    v_xor_b32 v17, v113, v15
    v_or_b32 v16, v16, v17
    v_xor_b32 v17, v115, v15
    v_or_b32 v16, v16, v17
    s_waitcnt vmcnt(8)
    v_xor_b32 v17, v117, v15
    v_or_b32 v16, v16, v17
    v_xor_b32 v17, v119, v15
    v_or_b32 v16, v16, v17
    s_waitcnt vmcnt(7)
    v_xor_b32 v17, v121, v15
    v_or_b32 v16, v16, v17
    v_xor_b32 v17, v123, v15
    v_or_b32 v16, v16, v17
    s_waitcnt vmcnt(6)
    v_xor_b32 v17, v125, v15
    v_or_b32 v16, v16, v17
    v_xor_b32 v17, v127, v15
    v_or_b32 v16, v16, v17
    s_waitcnt vmcnt(5)
    v_xor_b32 v17, v129, v15
    v_or_b32 v16, v16, v17
    v_xor_b32 v17, v131, v15
    v_or_b32 v16, v16, v17
    s_waitcnt vmcnt(4)
    v_xor_b32 v17, v133, v15
    v_or_b32 v16, v16, v17
    v_xor_b32 v17, v135, v15
    v_or_b32 v16, v16, v17
    v_cmp_ne_u32 vcc, 0, v16
    s_nop 0
    s_cmp_eq_u64 vcc, 0
    s_cbranch_scc1 fz_kernel_g2ok9
fz_kernel_g28:
    s_add_u32 s40, s44, 0
    buffer_load_dwordx4 v[108:111], v2, s[4:7], s40 offen offset:0 sc0 sc1
    buffer_load_dwordx4 v[112:115], v2, s[4:7], s40 offen offset:1024 sc0 sc1
    buffer_load_dwordx4 v[116:119], v2, s[4:7], s40 offen offset:2048 sc0 sc1
    buffer_load_dwordx4 v[120:123], v2, s[4:7], s40 offen offset:3072 sc0 sc1
    s_add_u32 s40, s44, 4096
    buffer_load_dwordx4 v[124:127], v2, s[4:7], s40 offen offset:0 sc0 sc1
    buffer_load_dwordx4 v[128:131], v2, s[4:7], s40 offen offset:1024 sc0 sc1
    buffer_load_dwordx4 v[132:135], v2, s[4:7], s40 offen offset:2048 sc0 sc1
    s_waitcnt vmcnt(6)
    v_xor_b32 v16, v109, v15
    v_xor_b32 v17, v111, v15
    v_or_b32 v16, v16, v17
    s_waitcnt vmcnt(5)
    v_xor_b32 v17, v113, v15
    v_or_b32 v16, v16, v17
    v_xor_b32 v17, v115, v15
    v_or_b32 v16, v16, v17
    s_waitcnt vmcnt(4)
    v_xor_b32 v17, v117, v15
    v_or_b32 v16, v16, v17
    v_xor_b32 v17, v119, v15
    v_or_b32 v16, v16, v17
    s_waitcnt vmcnt(3)
    v_xor_b32 v17, v121, v15
    v_or_b32 v16, v16, v17
    v_xor_b32 v17, v123, v15
    v_or_b32 v16, v16, v17
    s_waitcnt vmcnt(2)
    v_xor_b32 v17, v125, v15
    v_or_b32 v16, v16, v17
    v_xor_b32 v17, v127, v15
    v_or_b32 v16, v16, v17
    s_waitcnt vmcnt(1)
    v_xor_b32 v17, v129, v15
    v_or_b32 v16, v16, v17
    v_xor_b32 v17, v131, v15
    v_or_b32 v16, v16, v17
    s_waitcnt vmcnt(0)
    v_xor_b32 v17, v133, v15
    v_or_b32 v16, v16, v17
    v_xor_b32 v17, v135, v15
    v_or_b32 v16, v16, v17
    v_cmp_ne_u32 vcc, 0, v16
    s_nop 0
    s_cmp_eq_u64 vcc, 0
    s_cbranch_scc1 fz_kernel_g2ok9
    s_sleep 1
    s_sub_u32 s61, s61, 1
    s_cbranch_scc0 fz_kernel_g28
    s_mov_b32 s61, 0
fz_kernel_g2ok9:
    v_add_f32 v108, v108, v112
    v_add_f32 v110, v110, v114
    v_add_f32 v108, v108, v116
    v_add_f32 v110, v110, v118
    v_add_f32 v108, v108, v120
    v_add_f32 v110, v110, v122
    v_add_f32 v108, v108, v124
    v_add_f32 v110, v110, v126
    v_add_f32 v108, v108, v128
    v_add_f32 v110, v110, v130
    v_add_f32 v108, v108, v132
    v_add_f32 v110, v110, v134
    v_mov_b32 v16, v108
    v_mov_b32 v17, v110
    s_nop 0
    v_permlane32_swap_b32 v108, v16
    v_permlane32_swap_b32 v110, v17
    v_add_f32 v108, v108, v16
    v_add_f32 v109, v110, v17
    s_lshl_b32 s40, s24, 9
    s_add_u32 s40, s40, 147712
    v_and_b32 v18, 31, v1
    v_lshlrev_b32 v19, 3, v18
    v_add_u32 v19, s40, v19
    ds_write_b64 v19, v[108:109]
    v_lshlrev_b32 v19, 2, v18
    v_add_u32 v19, s40, v19
    s_waitcnt lgkmcnt(0)
    ds_read_b32 v16, v19
    ds_read_b32 v17, v19 offset:128
    s_lshl_b32 s40, s27, 18
    s_lshl_b32 s41, s36, 11
    s_add_u32 s40, s40, s41
    s_add_u32 s40, s40, 10485760
    s_waitcnt lgkmcnt(1)
    v_mul_f32 v16, 0x3a924925, v16
    s_waitcnt lgkmcnt(0)
    v_mul_f32 v17, 0x3a924925, v17
    v_fma_f32 v17, -v16, v16, v17
    v_max_f32 v17, 0, v17
    v_add_f32 v17, 0x3727c5ac, v17
    v_rsq_f32 v17, v17
    s_nop 0
    v_mul_f32 v16, v16, v17
    s_barrier
    v_fma_f32 v32, v32, v17, -v16
    v_fma_f32 v33, v33, v17, -v16
    v_fma_f32 v34, v34, v17, -v16
    v_fma_f32 v35, v35, v17, -v16
    v_fma_f32 v36, v36, v17, -v16
    v_fma_f32 v37, v37, v17, -v16
    v_fma_f32 v38, v38, v17, -v16
    v_fma_f32 v39, v39, v17, -v16
    v_fma_f32 v40, v40, v17, -v16
    v_fma_f32 v41, v41, v17, -v16
    v_fma_f32 v42, v42, v17, -v16
    v_fma_f32 v43, v43, v17, -v16
    v_fma_f32 v44, v44, v17, -v16
    v_fma_f32 v45, v45, v17, -v16
    v_fma_f32 v46, v46, v17, -v16
    v_fma_f32 v47, v47, v17, -v16
    v_fma_f32 v48, v48, v17, -v16
    v_fma_f32 v49, v49, v17, -v16
    v_fma_f32 v50, v50, v17, -v16
    v_fma_f32 v51, v51, v17, -v16
    v_fma_f32 v52, v52, v17, -v16
    v_fma_f32 v53, v53, v17, -v16
    v_fma_f32 v54, v54, v17, -v16
    v_fma_f32 v55, v55, v17, -v16
    v_fma_f32 v56, v56, v17, -v16
    v_fma_f32 v57, v57, v17, -v16
    v_fma_f32 v58, v58, v17, -v16
    v_fma_f32 v59, v59, v17, -v16
    v_fma_f32 v60, v60, v17, -v16
    v_fma_f32 v61, v61, v17, -v16
    v_fma_f32 v62, v62, v17, -v16
    v_fma_f32 v63, v63, v17, -v16
    v_cvt_pk_bf16_f32 v32, v32, v33
    v_cvt_pk_bf16_f32 v33, v34, v35
    v_cvt_pk_bf16_f32 v34, v36, v37
    v_cvt_pk_bf16_f32 v35, v38, v39
    v_cvt_pk_bf16_f32 v40, v40, v41
    v_cvt_pk_bf16_f32 v41, v42, v43
    v_cvt_pk_bf16_f32 v42, v44, v45
    v_cvt_pk_bf16_f32 v43, v46, v47
    v_cvt_pk_bf16_f32 v48, v48, v49
    v_cvt_pk_bf16_f32 v49, v50, v51
    v_cvt_pk_bf16_f32 v50, v52, v53
    v_cvt_pk_bf16_f32 v51, v54, v55
    v_cvt_pk_bf16_f32 v56, v56, v57
    v_cvt_pk_bf16_f32 v57, v58, v59
    v_cvt_pk_bf16_f32 v58, v60, v61
    v_cvt_pk_bf16_f32 v59, v62, v63
    ds_write_b128 v24, v[32:35]
    ds_write_b128 v25, v[40:43]
    ds_write_b128 v26, v[48:51]
    ds_write_b128 v27, v[56:59]
    s_add_u32 s43, s40, 131072
    s_waitcnt lgkmcnt(0)
    ds_read_b64_tr_b16 v[32:33], v28 offset:0
    ds_read_b64_tr_b16 v[34:35], v29 offset:512
    ds_read_b64_tr_b16 v[36:37], v28 offset:2048
    ds_read_b64_tr_b16 v[38:39], v29 offset:2560
    ds_read_b64_tr_b16 v[40:41], v30 offset:0
    ds_read_b64_tr_b16 v[42:43], v31 offset:512
    ds_read_b64_tr_b16 v[44:45], v30 offset:2048
    ds_read_b64_tr_b16 v[46:47], v31 offset:2560
    s_waitcnt lgkmcnt(6)
    buffer_store_dwordx4 v[32:35], v2, s[4:7], s40 offen offset:0 sc1
    s_waitcnt lgkmcnt(4)
    buffer_store_dwordx4 v[36:39], v2, s[4:7], s40 offen offset:1024 sc1
    s_waitcnt lgkmcnt(2)
    buffer_store_dwordx4 v[40:43], v2, s[4:7], s43 offen offset:0 sc1
    s_waitcnt lgkmcnt(0)
    buffer_store_dwordx4 v[44:47], v2, s[4:7], s43 offen offset:1024 sc1
    s_barrier
    s_branch k1_fin
k1_q:
    s_waitcnt vmcnt(1)
    v_xor_b32 v16, v161, v15
    s_waitcnt vmcnt(0)
    v_xor_b32 v17, v163, v15
    v_or_b32 v16, v16, v17
    v_xor_b32 v17, v157, v15
    v_or_b32 v16, v16, v17
    v_xor_b32 v17, v159, v15
    v_or_b32 v16, v16, v17
    v_cmp_ne_u32 vcc, 0, v16
    s_nop 0
    s_cmp_eq_u64 vcc, 0
    s_cbranch_scc1 fz_kernel_g1ok11
fz_kernel_g110:
    s_sleep 2
    buffer_load_dwordx4 v[156:159], v164, s[4:7], 0 offen sc0 sc1
    buffer_load_dwordx2 v[160:161], v165, s[4:7], s38 offen sc0 sc1
    buffer_load_dwordx2 v[162:163], v165, s[4:7], s39 offen sc0 sc1
    s_waitcnt vmcnt(1)
    v_xor_b32 v16, v161, v15
    s_waitcnt vmcnt(0)
    v_xor_b32 v17, v163, v15
    v_or_b32 v16, v16, v17
    v_xor_b32 v17, v157, v15
    v_or_b32 v16, v16, v17
    v_xor_b32 v17, v159, v15
    v_or_b32 v16, v16, v17
    v_cmp_ne_u32 vcc, 0, v16
    s_nop 0
    s_cmp_eq_u64 vcc, 0
    s_cbranch_scc1 fz_kernel_g1ok11
    s_sub_u32 s61, s61, 1
    s_cbranch_scc0 fz_kernel_g110
    s_mov_b32 s61, 0
fz_kernel_g1ok11:
    ds_write_b32 v20, v160
    ds_write_b32 v20, v162 offset:256
    s_waitcnt lgkmcnt(0)
    s_cmp_eq_u32 s34, 0
    s_cselect_b32 s40, 0x3eb8aa3b, 1.0
    v_mul_f32 v4, s40, v156
    v_mul_f32 v5, s40, v158
    s_lshl_b32 s40, s27, 19
    s_lshl_b32 s41, s36, 10
    s_add_u32 s40, s40, s41
    s_add_u32 s40, s40, 0
    ds_read_b128 v[108:111], v22 offset:0
    ds_read_b128 v[112:115], v22 offset:16
    ds_read_b128 v[116:119], v22 offset:64
    ds_read_b128 v[120:123], v22 offset:80
    ds_read_b128 v[124:127], v22 offset:128
    ds_read_b128 v[128:131], v22 offset:144
    ds_read_b128 v[132:135], v22 offset:192
    ds_read_b128 v[136:139], v22 offset:208
    v_pk_mul_f32 v[32:33], v[32:33], v[4:5] op_sel_hi:[1,0]
    v_pk_mul_f32 v[34:35], v[34:35], v[4:5] op_sel_hi:[1,0]
    v_pk_mul_f32 v[36:37], v[36:37], v[4:5] op_sel_hi:[1,0]
    v_pk_mul_f32 v[38:39], v[38:39], v[4:5] op_sel_hi:[1,0]
    v_pk_mul_f32 v[40:41], v[40:41], v[4:5] op_sel_hi:[1,0]
    v_pk_mul_f32 v[42:43], v[42:43], v[4:5] op_sel_hi:[1,0]
    v_pk_mul_f32 v[44:45], v[44:45], v[4:5] op_sel_hi:[1,0]
    v_pk_mul_f32 v[46:47], v[46:47], v[4:5] op_sel_hi:[1,0]
    v_pk_mul_f32 v[48:49], v[48:49], v[4:5] op_sel_hi:[1,0]
    v_pk_mul_f32 v[50:51], v[50:51], v[4:5] op_sel_hi:[1,0]
    v_pk_mul_f32 v[52:53], v[52:53], v[4:5] op_sel_hi:[1,0]
    v_pk_mul_f32 v[54:55], v[54:55], v[4:5] op_sel_hi:[1,0]
    v_pk_mul_f32 v[56:57], v[56:57], v[4:5] op_sel_hi:[1,0]
    v_pk_mul_f32 v[58:59], v[58:59], v[4:5] op_sel_hi:[1,0]
    v_pk_mul_f32 v[60:61], v[60:61], v[4:5] op_sel_hi:[1,0]
    v_pk_mul_f32 v[62:63], v[62:63], v[4:5] op_sel_hi:[1,0]
    s_waitcnt lgkmcnt(7)
    v_pk_fma_f32 v[32:33], v[108:109], v[4:5], v[32:33] op_sel:[0,1,0] op_sel_hi:[1,1,1] neg_lo:[1,0,0] neg_hi:[1,0,0]
    v_pk_fma_f32 v[34:35], v[110:111], v[4:5], v[34:35] op_sel:[0,1,0] op_sel_hi:[1,1,1] neg_lo:[1,0,0] neg_hi:[1,0,0]
    s_waitcnt lgkmcnt(6)
    v_pk_fma_f32 v[36:37], v[112:113], v[4:5], v[36:37] op_sel:[0,1,0] op_sel_hi:[1,1,1] neg_lo:[1,0,0] neg_hi:[1,0,0]
    v_pk_fma_f32 v[38:39], v[114:115], v[4:5], v[38:39] op_sel:[0,1,0] op_sel_hi:[1,1,1] neg_lo:[1,0,0] neg_hi:[1,0,0]
    s_waitcnt lgkmcnt(5)
    v_pk_fma_f32 v[40:41], v[116:117], v[4:5], v[40:41] op_sel:[0,1,0] op_sel_hi:[1,1,1] neg_lo:[1,0,0] neg_hi:[1,0,0]
    v_pk_fma_f32 v[42:43], v[118:119], v[4:5], v[42:43] op_sel:[0,1,0] op_sel_hi:[1,1,1] neg_lo:[1,0,0] neg_hi:[1,0,0]
    s_waitcnt lgkmcnt(4)
    v_pk_fma_f32 v[44:45], v[120:121], v[4:5], v[44:45] op_sel:[0,1,0] op_sel_hi:[1,1,1] neg_lo:[1,0,0] neg_hi:[1,0,0]
    v_pk_fma_f32 v[46:47], v[122:123], v[4:5], v[46:47] op_sel:[0,1,0] op_sel_hi:[1,1,1] neg_lo:[1,0,0] neg_hi:[1,0,0]
    s_waitcnt lgkmcnt(3)
    v_pk_fma_f32 v[48:49], v[124:125], v[4:5], v[48:49] op_sel:[0,1,0] op_sel_hi:[1,1,1] neg_lo:[1,0,0] neg_hi:[1,0,0]
    v_pk_fma_f32 v[50:51], v[126:127], v[4:5], v[50:51] op_sel:[0,1,0] op_sel_hi:[1,1,1] neg_lo:[1,0,0] neg_hi:[1,0,0]
    s_waitcnt lgkmcnt(2)
    v_pk_fma_f32 v[52:53], v[128:129], v[4:5], v[52:53] op_sel:[0,1,0] op_sel_hi:[1,1,1] neg_lo:[1,0,0] neg_hi:[1,0,0]
    v_pk_fma_f32 v[54:55], v[130:131], v[4:5], v[54:55] op_sel:[0,1,0] op_sel_hi:[1,1,1] neg_lo:[1,0,0] neg_hi:[1,0,0]
    s_waitcnt lgkmcnt(1)
    v_pk_fma_f32 v[56:57], v[132:133], v[4:5], v[56:57] op_sel:[0,1,0] op_sel_hi:[1,1,1] neg_lo:[1,0,0] neg_hi:[1,0,0]
    v_pk_fma_f32 v[58:59], v[134:135], v[4:5], v[58:59] op_sel:[0,1,0] op_sel_hi:[1,1,1] neg_lo:[1,0,0] neg_hi:[1,0,0]
    s_waitcnt lgkmcnt(0)
    v_pk_fma_f32 v[60:61], v[136:137], v[4:5], v[60:61] op_sel:[0,1,0] op_sel_hi:[1,1,1] neg_lo:[1,0,0] neg_hi:[1,0,0]
    v_pk_fma_f32 v[62:63], v[138:139], v[4:5], v[62:63] op_sel:[0,1,0] op_sel_hi:[1,1,1] neg_lo:[1,0,0] neg_hi:[1,0,0]
    v_cvt_pk_bf16_f32 v32, v32, v33
    v_cvt_pk_bf16_f32 v33, v34, v35
    v_cvt_pk_bf16_f32 v34, v36, v37
    v_cvt_pk_bf16_f32 v35, v38, v39
    v_cvt_pk_bf16_f32 v40, v40, v41
    v_cvt_pk_bf16_f32 v41, v42, v43
    v_cvt_pk_bf16_f32 v42, v44, v45
    v_cvt_pk_bf16_f32 v43, v46, v47
    v_cvt_pk_bf16_f32 v48, v48, v49
    v_cvt_pk_bf16_f32 v49, v50, v51
    v_cvt_pk_bf16_f32 v50, v52, v53
    v_cvt_pk_bf16_f32 v51, v54, v55
    v_cvt_pk_bf16_f32 v56, v56, v57
    v_cvt_pk_bf16_f32 v57, v58, v59
    v_cvt_pk_bf16_f32 v58, v60, v61
    v_cvt_pk_bf16_f32 v59, v62, v63
    s_cmp_eq_u32 s34, 2
    s_cbranch_scc1 fz_kernel_qv12
    buffer_store_dwordx4 v[32:35], v2, s[4:7], s40 offen sc1
    s_add_u32 s40, s40, 65536
    buffer_store_dwordx4 v[40:43], v2, s[4:7], s40 offen sc1
    s_add_u32 s40, s40, 65536
    buffer_store_dwordx4 v[48:51], v2, s[4:7], s40 offen sc1
    s_add_u32 s40, s40, 65536
    buffer_store_dwordx4 v[56:59], v2, s[4:7], s40 offen sc1
    s_add_u32 s40, s40, 65536
    s_branch fz_kernel_qd13
fz_kernel_qv12:
    ds_write_b128 v24, v[32:35]
    ds_write_b128 v25, v[40:43]
    ds_write_b128 v26, v[48:51]
    ds_write_b128 v27, v[56:59]
    s_add_u32 s43, s40, 131072
    s_waitcnt lgkmcnt(0)
    ds_read_b64_tr_b16 v[32:33], v28 offset:0
    ds_read_b64_tr_b16 v[34:35], v29 offset:512
    ds_read_b64_tr_b16 v[36:37], v28 offset:2048
    ds_read_b64_tr_b16 v[38:39], v29 offset:2560
    ds_read_b64_tr_b16 v[40:41], v30 offset:0
    ds_read_b64_tr_b16 v[42:43], v31 offset:512
    ds_read_b64_tr_b16 v[44:45], v30 offset:2048
    ds_read_b64_tr_b16 v[46:47], v31 offset:2560
    s_waitcnt lgkmcnt(6)
    buffer_store_dwordx4 v[32:35], v23, s[4:7], s40 offen offset:0 sc1
    s_waitcnt lgkmcnt(4)
    buffer_store_dwordx4 v[36:39], v23, s[4:7], s40 offen offset:512 sc1
    s_waitcnt lgkmcnt(2)
    buffer_store_dwordx4 v[40:43], v23, s[4:7], s43 offen offset:0 sc1
    s_waitcnt lgkmcnt(0)
    buffer_store_dwordx4 v[44:47], v23, s[4:7], s43 offen offset:512 sc1
    s_add_u32 s40, s40, 262144
fz_kernel_qd13:
    ds_read_b128 v[108:111], v22 offset:256
    ds_read_b128 v[112:115], v22 offset:272
    ds_read_b128 v[116:119], v22 offset:320
    ds_read_b128 v[120:123], v22 offset:336
    ds_read_b128 v[124:127], v22 offset:384
    ds_read_b128 v[128:131], v22 offset:400
    ds_read_b128 v[132:135], v22 offset:448
    ds_read_b128 v[136:139], v22 offset:464
    v_pk_mul_f32 v[64:65], v[64:65], v[4:5] op_sel_hi:[1,0]
    v_pk_mul_f32 v[66:67], v[66:67], v[4:5] op_sel_hi:[1,0]
    v_pk_mul_f32 v[68:69], v[68:69], v[4:5] op_sel_hi:[1,0]
    v_pk_mul_f32 v[70:71], v[70:71], v[4:5] op_sel_hi:[1,0]
    v_pk_mul_f32 v[72:73], v[72:73], v[4:5] op_sel_hi:[1,0]
    v_pk_mul_f32 v[74:75], v[74:75], v[4:5] op_sel_hi:[1,0]
    v_pk_mul_f32 v[76:77], v[76:77], v[4:5] op_sel_hi:[1,0]
    v_pk_mul_f32 v[78:79], v[78:79], v[4:5] op_sel_hi:[1,0]
    v_pk_mul_f32 v[80:81], v[80:81], v[4:5] op_sel_hi:[1,0]
    v_pk_mul_f32 v[82:83], v[82:83], v[4:5] op_sel_hi:[1,0]
    v_pk_mul_f32 v[84:85], v[84:85], v[4:5] op_sel_hi:[1,0]
    v_pk_mul_f32 v[86:87], v[86:87], v[4:5] op_sel_hi:[1,0]
    v_pk_mul_f32 v[88:89], v[88:89], v[4:5] op_sel_hi:[1,0]
    v_pk_mul_f32 v[90:91], v[90:91], v[4:5] op_sel_hi:[1,0]
    v_pk_mul_f32 v[92:93], v[92:93], v[4:5] op_sel_hi:[1,0]
    v_pk_mul_f32 v[94:95], v[94:95], v[4:5] op_sel_hi:[1,0]
    s_waitcnt lgkmcnt(7)
    v_pk_fma_f32 v[64:65], v[108:109], v[4:5], v[64:65] op_sel:[0,1,0] op_sel_hi:[1,1,1] neg_lo:[1,0,0] neg_hi:[1,0,0]
    v_pk_fma_f32 v[66:67], v[110:111], v[4:5], v[66:67] op_sel:[0,1,0] op_sel_hi:[1,1,1] neg_lo:[1,0,0] neg_hi:[1,0,0]
    s_waitcnt lgkmcnt(6)
    v_pk_fma_f32 v[68:69], v[112:113], v[4:5], v[68:69] op_sel:[0,1,0] op_sel_hi:[1,1,1] neg_lo:[1,0,0] neg_hi:[1,0,0]
    v_pk_fma_f32 v[70:71], v[114:115], v[4:5], v[70:71] op_sel:[0,1,0] op_sel_hi:[1,1,1] neg_lo:[1,0,0] neg_hi:[1,0,0]
    s_waitcnt lgkmcnt(5)
    v_pk_fma_f32 v[72:73], v[116:117], v[4:5], v[72:73] op_sel:[0,1,0] op_sel_hi:[1,1,1] neg_lo:[1,0,0] neg_hi:[1,0,0]
    v_pk_fma_f32 v[74:75], v[118:119], v[4:5], v[74:75] op_sel:[0,1,0] op_sel_hi:[1,1,1] neg_lo:[1,0,0] neg_hi:[1,0,0]
    s_waitcnt lgkmcnt(4)
    v_pk_fma_f32 v[76:77], v[120:121], v[4:5], v[76:77] op_sel:[0,1,0] op_sel_hi:[1,1,1] neg_lo:[1,0,0] neg_hi:[1,0,0]
    v_pk_fma_f32 v[78:79], v[122:123], v[4:5], v[78:79] op_sel:[0,1,0] op_sel_hi:[1,1,1] neg_lo:[1,0,0] neg_hi:[1,0,0]
    s_waitcnt lgkmcnt(3)
    v_pk_fma_f32 v[80:81], v[124:125], v[4:5], v[80:81] op_sel:[0,1,0] op_sel_hi:[1,1,1] neg_lo:[1,0,0] neg_hi:[1,0,0]
    v_pk_fma_f32 v[82:83], v[126:127], v[4:5], v[82:83] op_sel:[0,1,0] op_sel_hi:[1,1,1] neg_lo:[1,0,0] neg_hi:[1,0,0]
    s_waitcnt lgkmcnt(2)
    v_pk_fma_f32 v[84:85], v[128:129], v[4:5], v[84:85] op_sel:[0,1,0] op_sel_hi:[1,1,1] neg_lo:[1,0,0] neg_hi:[1,0,0]
    v_pk_fma_f32 v[86:87], v[130:131], v[4:5], v[86:87] op_sel:[0,1,0] op_sel_hi:[1,1,1] neg_lo:[1,0,0] neg_hi:[1,0,0]
    s_waitcnt lgkmcnt(1)
    v_pk_fma_f32 v[88:89], v[132:133], v[4:5], v[88:89] op_sel:[0,1,0] op_sel_hi:[1,1,1] neg_lo:[1,0,0] neg_hi:[1,0,0]
    v_pk_fma_f32 v[90:91], v[134:135], v[4:5], v[90:91] op_sel:[0,1,0] op_sel_hi:[1,1,1] neg_lo:[1,0,0] neg_hi:[1,0,0]
    s_waitcnt lgkmcnt(0)
    v_pk_fma_f32 v[92:93], v[136:137], v[4:5], v[92:93] op_sel:[0,1,0] op_sel_hi:[1,1,1] neg_lo:[1,0,0] neg_hi:[1,0,0]
    v_pk_fma_f32 v[94:95], v[138:139], v[4:5], v[94:95] op_sel:[0,1,0] op_sel_hi:[1,1,1] neg_lo:[1,0,0] neg_hi:[1,0,0]
    v_cvt_pk_bf16_f32 v64, v64, v65
    v_cvt_pk_bf16_f32 v65, v66, v67
    v_cvt_pk_bf16_f32 v66, v68, v69
    v_cvt_pk_bf16_f32 v67, v70, v71
    v_cvt_pk_bf16_f32 v72, v72, v73
    v_cvt_pk_bf16_f32 v73, v74, v75
    v_cvt_pk_bf16_f32 v74, v76, v77
    v_cvt_pk_bf16_f32 v75, v78, v79
    v_cvt_pk_bf16_f32 v80, v80, v81
    v_cvt_pk_bf16_f32 v81, v82, v83
    v_cvt_pk_bf16_f32 v82, v84, v85
    v_cvt_pk_bf16_f32 v83, v86, v87
    v_cvt_pk_bf16_f32 v88, v88, v89
    v_cvt_pk_bf16_f32 v89, v90, v91
    v_cvt_pk_bf16_f32 v90, v92, v93
    v_cvt_pk_bf16_f32 v91, v94, v95
    s_cmp_eq_u32 s34, 2
    s_cbranch_scc1 fz_kernel_qv14
    buffer_store_dwordx4 v[64:67], v2, s[4:7], s40 offen sc1
    s_add_u32 s40, s40, 65536
    buffer_store_dwordx4 v[72:75], v2, s[4:7], s40 offen sc1
    s_add_u32 s40, s40, 65536
    buffer_store_dwordx4 v[80:83], v2, s[4:7], s40 offen sc1
    s_add_u32 s40, s40, 65536
    buffer_store_dwordx4 v[88:91], v2, s[4:7], s40 offen sc1
    s_add_u32 s40, s40, 65536
    s_branch fz_kernel_qd15
fz_kernel_qv14:
    ds_write_b128 v24, v[64:67]
    ds_write_b128 v25, v[72:75]
    ds_write_b128 v26, v[80:83]
    ds_write_b128 v27, v[88:91]
    s_add_u32 s43, s40, 131072
    s_waitcnt lgkmcnt(0)
    ds_read_b64_tr_b16 v[64:65], v28 offset:0
    ds_read_b64_tr_b16 v[66:67], v29 offset:512
    ds_read_b64_tr_b16 v[68:69], v28 offset:2048
    ds_read_b64_tr_b16 v[70:71], v29 offset:2560
    ds_read_b64_tr_b16 v[72:73], v30 offset:0
    ds_read_b64_tr_b16 v[74:75], v31 offset:512
    ds_read_b64_tr_b16 v[76:77], v30 offset:2048
    ds_read_b64_tr_b16 v[78:79], v31 offset:2560
    s_waitcnt lgkmcnt(6)
    buffer_store_dwordx4 v[64:67], v23, s[4:7], s40 offen offset:0 sc1
    s_waitcnt lgkmcnt(4)
    buffer_store_dwordx4 v[68:71], v23, s[4:7], s40 offen offset:512 sc1
    s_waitcnt lgkmcnt(2)
    buffer_store_dwordx4 v[72:75], v23, s[4:7], s43 offen offset:0 sc1
    s_waitcnt lgkmcnt(0)
    buffer_store_dwordx4 v[76:79], v23, s[4:7], s43 offen offset:512 sc1
    s_add_u32 s40, s40, 262144
fz_kernel_qd15:
    s_branch k1_clb
k1_loader:
    s_setprio 3
    s_lshl_b32 s32, s28, 12
    v_lshrrev_b32 v16, 3, v1
    v_and_b32 v17, 7, v1
    v_lshrrev_b32 v18, 1, v16
    v_xor_b32 v18, v18, v17
    v_lshlrev_b32 v18, 4, v18
    v_lshl_add_u32 v18, v16, 10, v18
    s_lshl_b32 s45, s26, 17
    s_lshl_b32 s46, s28, 15
    s_add_u32 s45, s45, s46
    v_add_u32 v3, s45, v18
    v_xor_b32 v18, 64, v18
    s_add_u32 s45, s45, 8192
    v_add_u32 v4, s45, v18
    v_lshlrev_b32 v18, 1, v16
    v_and_b32 v18, 4, v18
    v_xor_b32 v18, v18, v17
    v_lshlrev_b32 v18, 4, v18
    v_mul_u32_u24 v19, 3584, v16
    v_add_u32 v5, v19, v18
    v_mul_u32_u24 v19, 3072, v16
    v_add_u32 v6, v19, v18
    s_lshr_b32 s41, s28, 1
    s_and_b32 s42, s28, 1
    s_lshl_b32 s30, s27, 7
    s_cmp_eq_u32 s41, 0
    s_cselect_b32 s43, 1792, 0
    s_add_u32 s30, s30, s43
    s_mul_i32 s43, s42, 114688
    s_add_u32 s30, s30, s43
    s_lshl_b32 s31, s27, 8
    s_lshl_b32 s43, s41, 7
    s_add_u32 s31, s31, s43
    s_mul_i32 s43, s42, 98304
    s_add_u32 s31, s31, s43
    s_add_u32 s33, s32, 16384
    s_and_b32 s43, s2, 0
    s_lshl_b32 s29, s43, 7
    s_mul_i32 s44, s43, 229376
    s_add_u32 s30, s30, s44
    s_mul_i32 s44, s43, 196608
    s_add_u32 s31, s31, s44
    s_waitcnt lgkmcnt(0)
    s_add_u32 m0, s32, 0
    s_nop 0
    buffer_load_dwordx4 v3, s[8:11], s29 offen lds
    s_add_u32 m0, s32, 1024
    s_nop 0
    buffer_load_dwordx4 v4, s[8:11], s29 offen lds
    s_add_u32 m0, s32, 2048
    s_add_u32 s40, s29, 16384
    buffer_load_dwordx4 v3, s[8:11], s40 offen lds
    s_add_u32 m0, s32, 3072
    s_nop 0
    buffer_load_dwordx4 v4, s[8:11], s40 offen lds
    s_add_u32 m0, s33, 0
    s_nop 0
    buffer_load_dwordx4 v5, s[16:19], s30 offen lds
    s_add_u32 s30, s30, 28672
    s_add_u32 m0, s33, 1024
    s_nop 0
    buffer_load_dwordx4 v5, s[16:19], s30 offen lds
    s_add_u32 s30, s30, 28672
    s_add_u32 m0, s33, 2048
    s_nop 0
    buffer_load_dwordx4 v5, s[16:19], s30 offen lds
    s_add_u32 s30, s30, 28672
    s_add_u32 m0, s33, 3072
    s_nop 0
    buffer_load_dwordx4 v5, s[16:19], s30 offen lds
    s_add_u32 s30, s30, 143360
    s_add_u32 s29, s29, 128
    s_and_b32 s29, s29, 1023
    s_cselect_b32 s40, 0, 1835008
    s_sub_u32 s30, s30, s40
    s_add_u32 m0, s32, 32768
    s_nop 0
    buffer_load_dwordx4 v3, s[8:11], s29 offen lds
    s_add_u32 m0, s32, 33792
    s_nop 0
    buffer_load_dwordx4 v4, s[8:11], s29 offen lds
    s_add_u32 m0, s32, 34816
    s_add_u32 s40, s29, 16384
    buffer_load_dwordx4 v3, s[8:11], s40 offen lds
    s_add_u32 m0, s32, 35840
    s_nop 0
    buffer_load_dwordx4 v4, s[8:11], s40 offen lds
    s_add_u32 m0, s33, 32768
    s_nop 0
    buffer_load_dwordx4 v5, s[16:19], s30 offen lds
    s_add_u32 s30, s30, 28672
    s_add_u32 m0, s33, 33792
    s_nop 0
    buffer_load_dwordx4 v5, s[16:19], s30 offen lds
    s_add_u32 s30, s30, 28672
    s_add_u32 m0, s33, 34816
    s_nop 0
    buffer_load_dwordx4 v5, s[16:19], s30 offen lds
    s_add_u32 s30, s30, 28672
    s_add_u32 m0, s33, 35840
    s_nop 0
    buffer_load_dwordx4 v5, s[16:19], s30 offen lds
    s_add_u32 s30, s30, 143360
    s_add_u32 s29, s29, 128
    s_and_b32 s29, s29, 1023
    s_cselect_b32 s40, 0, 1835008
    s_sub_u32 s30, s30, s40
    v_mov_b32 v7, 147520
    v_mov_b32 v8, 1
    s_waitcnt vmcnt(8)
    s_waitcnt lgkmcnt(0)
    s_barrier
    s_add_u32 m0, s32, 65536
    s_nop 0
    buffer_load_dwordx4 v3, s[8:11], s29 offen lds
    s_add_u32 m0, s32, 66560
    s_nop 0
    buffer_load_dwordx4 v4, s[8:11], s29 offen lds
    s_add_u32 m0, s32, 67584
    s_add_u32 s40, s29, 16384
    buffer_load_dwordx4 v3, s[8:11], s40 offen lds
    s_add_u32 m0, s32, 68608
    s_nop 0
    buffer_load_dwordx4 v4, s[8:11], s40 offen lds
    s_add_u32 m0, s33, 65536
    s_nop 0
    buffer_load_dwordx4 v5, s[16:19], s30 offen lds
    s_add_u32 s30, s30, 28672
    s_add_u32 m0, s33, 66560
    s_nop 0
    buffer_load_dwordx4 v5, s[16:19], s30 offen lds
    s_add_u32 s30, s30, 28672
    s_add_u32 m0, s33, 67584
    s_nop 0
    buffer_load_dwordx4 v5, s[16:19], s30 offen lds
    s_add_u32 s30, s30, 28672
    s_add_u32 m0, s33, 68608
    s_nop 0
    buffer_load_dwordx4 v5, s[16:19], s30 offen lds
    s_add_u32 s30, s30, 143360
    s_add_u32 s29, s29, 128
    s_and_b32 s29, s29, 1023
    s_cselect_b32 s40, 0, 1835008
    s_sub_u32 s30, s30, s40
    s_add_u32 m0, s32, 98304
    s_nop 0
    buffer_load_dwordx4 v3, s[8:11], s29 offen lds
    s_add_u32 m0, s32, 99328
    s_nop 0
    buffer_load_dwordx4 v4, s[8:11], s29 offen lds
    s_add_u32 m0, s32, 100352
    s_add_u32 s40, s29, 16384
    buffer_load_dwordx4 v3, s[8:11], s40 offen lds
    s_add_u32 m0, s32, 101376
    s_nop 0
    buffer_load_dwordx4 v4, s[8:11], s40 offen lds
    s_add_u32 m0, s33, 98304
    s_nop 0
    buffer_load_dwordx4 v5, s[16:19], s30 offen lds
    s_add_u32 s30, s30, 28672
    s_add_u32 m0, s33, 99328
    s_nop 0
    buffer_load_dwordx4 v5, s[16:19], s30 offen lds
    s_add_u32 s30, s30, 28672
    s_add_u32 m0, s33, 100352
    s_nop 0
    buffer_load_dwordx4 v5, s[16:19], s30 offen lds
    s_add_u32 s30, s30, 28672
    s_add_u32 m0, s33, 101376
    s_nop 0
    buffer_load_dwordx4 v5, s[16:19], s30 offen lds
    s_add_u32 s30, s30, 143360
    s_add_u32 s29, s29, 128
    s_and_b32 s29, s29, 1023
    s_cselect_b32 s40, 0, 1835008
    s_sub_u32 s30, s30, s40
    s_waitcnt vmcnt(16)
    s_waitcnt lgkmcnt(0)
    s_barrier
    s_add_u32 m0, s32, 0
    s_nop 0
    buffer_load_dwordx4 v3, s[8:11], s29 offen lds
    s_add_u32 m0, s32, 1024
    s_nop 0
    buffer_load_dwordx4 v4, s[8:11], s29 offen lds
    s_add_u32 m0, s32, 2048
    s_add_u32 s40, s29, 16384
    buffer_load_dwordx4 v3, s[8:11], s40 offen lds
    s_add_u32 m0, s32, 3072
    s_nop 0
    buffer_load_dwordx4 v4, s[8:11], s40 offen lds
    s_add_u32 m0, s33, 0
    s_nop 0
    buffer_load_dwordx4 v5, s[16:19], s30 offen lds
    s_add_u32 s30, s30, 28672
    s_add_u32 m0, s33, 1024
    s_nop 0
    buffer_load_dwordx4 v5, s[16:19], s30 offen lds
    s_add_u32 s30, s30, 28672
    s_add_u32 m0, s33, 2048
    s_nop 0
    buffer_load_dwordx4 v5, s[16:19], s30 offen lds
    s_add_u32 s30, s30, 28672
    s_add_u32 m0, s33, 3072
    s_nop 0
    buffer_load_dwordx4 v5, s[16:19], s30 offen lds
    s_add_u32 s30, s30, 143360
    s_add_u32 s29, s29, 128
    s_and_b32 s29, s29, 1023
    s_cselect_b32 s40, 0, 1835008
    s_sub_u32 s30, s30, s40
    s_waitcnt vmcnt(16)
    s_waitcnt lgkmcnt(0)
    s_barrier
    s_add_u32 m0, s32, 32768
    s_nop 0
    buffer_load_dwordx4 v3, s[8:11], s29 offen lds
    s_add_u32 m0, s32, 33792
    s_nop 0
    buffer_load_dwordx4 v4, s[8:11], s29 offen lds
    s_add_u32 m0, s32, 34816
    s_add_u32 s40, s29, 16384
    buffer_load_dwordx4 v3, s[8:11], s40 offen lds
    s_add_u32 m0, s32, 35840
    s_nop 0
    buffer_load_dwordx4 v4, s[8:11], s40 offen lds
    s_add_u32 m0, s33, 32768
    s_nop 0
    buffer_load_dwordx4 v5, s[16:19], s30 offen lds
    s_add_u32 s30, s30, 28672
    s_add_u32 m0, s33, 33792
    s_nop 0
    buffer_load_dwordx4 v5, s[16:19], s30 offen lds
    s_add_u32 s30, s30, 28672
    s_add_u32 m0, s33, 34816
    s_nop 0
    buffer_load_dwordx4 v5, s[16:19], s30 offen lds
    s_add_u32 s30, s30, 28672
    s_add_u32 m0, s33, 35840
    s_nop 0
    buffer_load_dwordx4 v5, s[16:19], s30 offen lds
    s_add_u32 s30, s30, 143360
    s_add_u32 s29, s29, 128
    s_and_b32 s29, s29, 1023
    s_cselect_b32 s40, 0, 1835008
    s_sub_u32 s30, s30, s40
    s_waitcnt vmcnt(16)
    s_waitcnt lgkmcnt(0)
    s_barrier
    s_add_u32 m0, s32, 65536
    s_nop 0
    buffer_load_dwordx4 v3, s[8:11], s29 offen lds
    s_add_u32 m0, s32, 66560
    s_nop 0
    buffer_load_dwordx4 v4, s[8:11], s29 offen lds
    s_add_u32 m0, s32, 67584
    s_add_u32 s40, s29, 16384
    buffer_load_dwordx4 v3, s[8:11], s40 offen lds
    s_add_u32 m0, s32, 68608
    s_nop 0
    buffer_load_dwordx4 v4, s[8:11], s40 offen lds
    s_add_u32 m0, s33, 65536
    s_nop 0
    buffer_load_dwordx4 v5, s[16:19], s30 offen lds
    s_add_u32 s30, s30, 28672
    s_add_u32 m0, s33, 66560
    s_nop 0
    buffer_load_dwordx4 v5, s[16:19], s30 offen lds
    s_add_u32 s30, s30, 28672
    s_add_u32 m0, s33, 67584
    s_nop 0
    buffer_load_dwordx4 v5, s[16:19], s30 offen lds
    s_add_u32 s30, s30, 28672
    s_add_u32 m0, s33, 68608
    s_nop 0
    buffer_load_dwordx4 v5, s[16:19], s30 offen lds
    s_add_u32 s30, s30, 143360
    s_add_u32 s29, s29, 128
    s_and_b32 s29, s29, 1023
    s_cselect_b32 s40, 0, 1835008
    s_sub_u32 s30, s30, s40
    s_waitcnt vmcnt(16)
    s_waitcnt lgkmcnt(0)
    s_barrier
    s_add_u32 m0, s32, 98304
    s_nop 0
    buffer_load_dwordx4 v3, s[8:11], s29 offen lds
    s_add_u32 m0, s32, 99328
    s_nop 0
    buffer_load_dwordx4 v4, s[8:11], s29 offen lds
    s_add_u32 m0, s32, 100352
    s_add_u32 s40, s29, 16384
    buffer_load_dwordx4 v3, s[8:11], s40 offen lds
    s_add_u32 m0, s32, 101376
    s_nop 0
    buffer_load_dwordx4 v4, s[8:11], s40 offen lds
    s_add_u32 m0, s33, 98304
    s_nop 0
    buffer_load_dwordx4 v5, s[16:19], s30 offen lds
    s_add_u32 s30, s30, 28672
    s_add_u32 m0, s33, 99328
    s_nop 0
    buffer_load_dwordx4 v5, s[16:19], s30 offen lds
    s_add_u32 s30, s30, 28672
    s_add_u32 m0, s33, 100352
    s_nop 0
    buffer_load_dwordx4 v5, s[16:19], s30 offen lds
    s_add_u32 s30, s30, 28672
    s_add_u32 m0, s33, 101376
    s_nop 0
    buffer_load_dwordx4 v5, s[16:19], s30 offen lds
    s_add_u32 s30, s30, 143360
    s_add_u32 s29, s29, 128
    s_and_b32 s29, s29, 1023
    s_cselect_b32 s40, 0, 1835008
    s_sub_u32 s30, s30, s40
    s_cmp_ge_u32 s27, 12
    s_cbranch_scc1 k1_ltail
    s_waitcnt vmcnt(16)
    s_waitcnt lgkmcnt(0)
    s_barrier
    s_add_u32 m0, s32, 0
    s_nop 0
    buffer_load_dwordx4 v3, s[8:11], s29 offen lds
    s_add_u32 m0, s32, 1024
    s_nop 0
    buffer_load_dwordx4 v4, s[8:11], s29 offen lds
    s_add_u32 m0, s32, 2048
    s_add_u32 s40, s29, 16384
    buffer_load_dwordx4 v3, s[8:11], s40 offen lds
    s_add_u32 m0, s32, 3072
    s_nop 0
    buffer_load_dwordx4 v4, s[8:11], s40 offen lds
    s_add_u32 m0, s33, 0
    s_nop 0
    buffer_load_dwordx4 v6, s[12:15], s31 offen lds
    s_add_u32 s31, s31, 24576
    s_add_u32 m0, s33, 1024
    s_nop 0
    buffer_load_dwordx4 v6, s[12:15], s31 offen lds
    s_add_u32 s31, s31, 24576
    s_add_u32 m0, s33, 2048
    s_nop 0
    buffer_load_dwordx4 v6, s[12:15], s31 offen lds
    s_add_u32 s31, s31, 24576
    s_add_u32 m0, s33, 3072
    s_nop 0
    buffer_load_dwordx4 v6, s[12:15], s31 offen lds
    s_add_u32 s31, s31, 122880
    s_add_u32 s29, s29, 128
    s_and_b32 s29, s29, 1023
    s_cselect_b32 s40, 0, 1572864
    s_sub_u32 s31, s31, s40
    s_waitcnt vmcnt(16)
    s_waitcnt lgkmcnt(0)
    s_barrier
    s_add_u32 m0, s32, 32768
    s_nop 0
    buffer_load_dwordx4 v3, s[8:11], s29 offen lds
    s_add_u32 m0, s32, 33792
    s_nop 0
    buffer_load_dwordx4 v4, s[8:11], s29 offen lds
    s_add_u32 m0, s32, 34816
    s_add_u32 s40, s29, 16384
    buffer_load_dwordx4 v3, s[8:11], s40 offen lds
    s_add_u32 m0, s32, 35840
    s_nop 0
    buffer_load_dwordx4 v4, s[8:11], s40 offen lds
    s_add_u32 m0, s33, 32768
    s_nop 0
    buffer_load_dwordx4 v6, s[12:15], s31 offen lds
    s_add_u32 s31, s31, 24576
    s_add_u32 m0, s33, 33792
    s_nop 0
    buffer_load_dwordx4 v6, s[12:15], s31 offen lds
    s_add_u32 s31, s31, 24576
    s_add_u32 m0, s33, 34816
    s_nop 0
    buffer_load_dwordx4 v6, s[12:15], s31 offen lds
    s_add_u32 s31, s31, 24576
    s_add_u32 m0, s33, 35840
    s_nop 0
    buffer_load_dwordx4 v6, s[12:15], s31 offen lds
    s_add_u32 s31, s31, 122880
    s_add_u32 s29, s29, 128
    s_and_b32 s29, s29, 1023
    s_cselect_b32 s40, 0, 1572864
    s_sub_u32 s31, s31, s40
    s_waitcnt vmcnt(16)
    s_waitcnt lgkmcnt(0)
    s_barrier
    s_add_u32 m0, s32, 65536
    s_nop 0
    buffer_load_dwordx4 v3, s[8:11], s29 offen lds
    s_add_u32 m0, s32, 66560
    s_nop 0
    buffer_load_dwordx4 v4, s[8:11], s29 offen lds
    s_add_u32 m0, s32, 67584
    s_add_u32 s40, s29, 16384
    buffer_load_dwordx4 v3, s[8:11], s40 offen lds
    s_add_u32 m0, s32, 68608
    s_nop 0
    buffer_load_dwordx4 v4, s[8:11], s40 offen lds
    s_add_u32 m0, s33, 65536
    s_nop 0
    buffer_load_dwordx4 v6, s[12:15], s31 offen lds
    s_add_u32 s31, s31, 24576
    s_add_u32 m0, s33, 66560
    s_nop 0
    buffer_load_dwordx4 v6, s[12:15], s31 offen lds
    s_add_u32 s31, s31, 24576
    s_add_u32 m0, s33, 67584
    s_nop 0
    buffer_load_dwordx4 v6, s[12:15], s31 offen lds
    s_add_u32 s31, s31, 24576
    s_add_u32 m0, s33, 68608
    s_nop 0
    buffer_load_dwordx4 v6, s[12:15], s31 offen lds
    s_add_u32 s31, s31, 122880
    s_add_u32 s29, s29, 128
    s_and_b32 s29, s29, 1023
    s_cselect_b32 s40, 0, 1572864
    s_sub_u32 s31, s31, s40
    s_waitcnt vmcnt(16)
    s_waitcnt lgkmcnt(0)
    s_barrier
    s_add_u32 m0, s32, 98304
    s_nop 0
    buffer_load_dwordx4 v3, s[8:11], s29 offen lds
    s_add_u32 m0, s32, 99328
    s_nop 0
    buffer_load_dwordx4 v4, s[8:11], s29 offen lds
    s_add_u32 m0, s32, 100352
    s_add_u32 s40, s29, 16384
    buffer_load_dwordx4 v3, s[8:11], s40 offen lds
    s_add_u32 m0, s32, 101376
    s_nop 0
    buffer_load_dwordx4 v4, s[8:11], s40 offen lds
    s_add_u32 m0, s33, 98304
    s_nop 0
    buffer_load_dwordx4 v6, s[12:15], s31 offen lds
    s_add_u32 s31, s31, 24576
    s_add_u32 m0, s33, 99328
    s_nop 0
    buffer_load_dwordx4 v6, s[12:15], s31 offen lds
    s_add_u32 s31, s31, 24576
    s_add_u32 m0, s33, 100352
    s_nop 0
    buffer_load_dwordx4 v6, s[12:15], s31 offen lds
    s_add_u32 s31, s31, 24576
    s_add_u32 m0, s33, 101376
    s_nop 0
    buffer_load_dwordx4 v6, s[12:15], s31 offen lds
    s_add_u32 s31, s31, 122880
    s_add_u32 s29, s29, 128
    s_and_b32 s29, s29, 1023
    s_cselect_b32 s40, 0, 1572864
    s_sub_u32 s31, s31, s40
    s_waitcnt vmcnt(16)
    s_waitcnt lgkmcnt(0)
    s_barrier
    s_add_u32 m0, s32, 0
    s_nop 0
    buffer_load_dwordx4 v3, s[8:11], s29 offen lds
    s_add_u32 m0, s32, 1024
    s_nop 0
    buffer_load_dwordx4 v4, s[8:11], s29 offen lds
    s_add_u32 m0, s32, 2048
    s_add_u32 s40, s29, 16384
    buffer_load_dwordx4 v3, s[8:11], s40 offen lds
    s_add_u32 m0, s32, 3072
    s_nop 0
    buffer_load_dwordx4 v4, s[8:11], s40 offen lds
    s_add_u32 m0, s33, 0
    s_nop 0
    buffer_load_dwordx4 v6, s[12:15], s31 offen lds
    s_add_u32 s31, s31, 24576
    s_add_u32 m0, s33, 1024
    s_nop 0
    buffer_load_dwordx4 v6, s[12:15], s31 offen lds
    s_add_u32 s31, s31, 24576
    s_add_u32 m0, s33, 2048
    s_nop 0
    buffer_load_dwordx4 v6, s[12:15], s31 offen lds
    s_add_u32 s31, s31, 24576
    s_add_u32 m0, s33, 3072
    s_nop 0
    buffer_load_dwordx4 v6, s[12:15], s31 offen lds
    s_add_u32 s31, s31, 122880
    s_add_u32 s29, s29, 128
    s_and_b32 s29, s29, 1023
    s_cselect_b32 s40, 0, 1572864
    s_sub_u32 s31, s31, s40
    s_waitcnt vmcnt(16)
    s_waitcnt lgkmcnt(0)
    s_barrier
    s_add_u32 m0, s32, 32768
    s_nop 0
    buffer_load_dwordx4 v3, s[8:11], s29 offen lds
    s_add_u32 m0, s32, 33792
    s_nop 0
    buffer_load_dwordx4 v4, s[8:11], s29 offen lds
    s_add_u32 m0, s32, 34816
    s_add_u32 s40, s29, 16384
    buffer_load_dwordx4 v3, s[8:11], s40 offen lds
    s_add_u32 m0, s32, 35840
    s_nop 0
    buffer_load_dwordx4 v4, s[8:11], s40 offen lds
    s_add_u32 m0, s33, 32768
    s_nop 0
    buffer_load_dwordx4 v6, s[12:15], s31 offen lds
    s_add_u32 s31, s31, 24576
    s_add_u32 m0, s33, 33792
    s_nop 0
    buffer_load_dwordx4 v6, s[12:15], s31 offen lds
    s_add_u32 s31, s31, 24576
    s_add_u32 m0, s33, 34816
    s_nop 0
    buffer_load_dwordx4 v6, s[12:15], s31 offen lds
    s_add_u32 s31, s31, 24576
    s_add_u32 m0, s33, 35840
    s_nop 0
    buffer_load_dwordx4 v6, s[12:15], s31 offen lds
    s_add_u32 s31, s31, 122880
    s_add_u32 s29, s29, 128
    s_and_b32 s29, s29, 1023
    s_cselect_b32 s40, 0, 1572864
    s_sub_u32 s31, s31, s40
    s_waitcnt vmcnt(16)
    s_waitcnt lgkmcnt(0)
    s_barrier
    s_add_u32 m0, s32, 65536
    s_nop 0
    buffer_load_dwordx4 v3, s[8:11], s29 offen lds
    s_add_u32 m0, s32, 66560
    s_nop 0
    buffer_load_dwordx4 v4, s[8:11], s29 offen lds
    s_add_u32 m0, s32, 67584
    s_add_u32 s40, s29, 16384
    buffer_load_dwordx4 v3, s[8:11], s40 offen lds
    s_add_u32 m0, s32, 68608
    s_nop 0
    buffer_load_dwordx4 v4, s[8:11], s40 offen lds
    s_add_u32 m0, s33, 65536
    s_nop 0
    buffer_load_dwordx4 v6, s[12:15], s31 offen lds
    s_add_u32 s31, s31, 24576
    s_add_u32 m0, s33, 66560
    s_nop 0
    buffer_load_dwordx4 v6, s[12:15], s31 offen lds
    s_add_u32 s31, s31, 24576
    s_add_u32 m0, s33, 67584
    s_nop 0
    buffer_load_dwordx4 v6, s[12:15], s31 offen lds
    s_add_u32 s31, s31, 24576
    s_add_u32 m0, s33, 68608
    s_nop 0
    buffer_load_dwordx4 v6, s[12:15], s31 offen lds
    s_add_u32 s31, s31, 122880
    s_add_u32 s29, s29, 128
    s_and_b32 s29, s29, 1023
    s_cselect_b32 s40, 0, 1572864
    s_sub_u32 s31, s31, s40
    s_waitcnt vmcnt(16)
    s_waitcnt lgkmcnt(0)
    s_barrier
    s_add_u32 m0, s32, 98304
    s_nop 0
    buffer_load_dwordx4 v3, s[8:11], s29 offen lds
    s_add_u32 m0, s32, 99328
    s_nop 0
    buffer_load_dwordx4 v4, s[8:11], s29 offen lds
    s_add_u32 m0, s32, 100352
    s_add_u32 s40, s29, 16384
    buffer_load_dwordx4 v3, s[8:11], s40 offen lds
    s_add_u32 m0, s32, 101376
    s_nop 0
    buffer_load_dwordx4 v4, s[8:11], s40 offen lds
    s_add_u32 m0, s33, 98304
    s_nop 0
    buffer_load_dwordx4 v6, s[12:15], s31 offen lds
    s_add_u32 s31, s31, 24576
    s_add_u32 m0, s33, 99328
    s_nop 0
    buffer_load_dwordx4 v6, s[12:15], s31 offen lds
    s_add_u32 s31, s31, 24576
    s_add_u32 m0, s33, 100352
    s_nop 0
    buffer_load_dwordx4 v6, s[12:15], s31 offen lds
    s_add_u32 s31, s31, 24576
    s_add_u32 m0, s33, 101376
    s_nop 0
    buffer_load_dwordx4 v6, s[12:15], s31 offen lds
    s_add_u32 s31, s31, 122880
    s_add_u32 s29, s29, 128
    s_and_b32 s29, s29, 1023
    s_cselect_b32 s40, 0, 1572864
    s_sub_u32 s31, s31, s40
    s_waitcnt vmcnt(16)
    s_waitcnt lgkmcnt(0)
    s_barrier
    s_waitcnt vmcnt(8)
    s_waitcnt lgkmcnt(0)
    s_barrier
    s_waitcnt vmcnt(0)
    s_waitcnt lgkmcnt(0)
    s_barrier
    s_branch k1_ldone
k1_ltail:
    s_waitcnt vmcnt(16)
    s_barrier
    s_waitcnt vmcnt(8)
    s_barrier
    s_waitcnt vmcnt(0)
    s_barrier
    s_barrier
    s_barrier
    s_barrier
    s_barrier
    s_barrier
    s_barrier
    s_barrier
    s_barrier
k1_ldone:
    v_mov_b32 v16, 147456
    ds_read_b32 v15, v16
    s_waitcnt lgkmcnt(0)
    v_readfirstlane_b32 s99, v15
    s_branch k1_fin
k1_helper:
    s_waitcnt lgkmcnt(0)
    v_mov_b32 v15, 0
    s_or_b32 s44, s2, s24
    s_cmp_lg_u32 s44, 0
    s_cbranch_scc1 k1_nonce_done
    s_or_b32 s54, s54, 1
    v_mov_b32 v15, s54
    v_lshlrev_b32 v19, 2, v1
    buffer_store_dword v15, v19, s[20:23], 0 offen offset:128 sc0 sc1
k1_nonce_done:
    s_cmp_lt_u32 s24, 8
    s_cbranch_scc1 k1_hcol
    s_setprio 2
    s_and_b32 s46, s2, 7
    s_lshl_b32 s46, s46, 2
    s_lshr_b32 s47, s2, 3
    s_add_u32 s46, s46, s47
    s_lshl_b32 s46, s46, 2
    s_add_u32 s46, s46, s24
    s_sub_u32 s46, s46, 8
    s_lshl_b32 s47, s46, 14
    v_lshrrev_b32 v16, 3, v1
    v_and_b32 v17, 7, v1
    v_lshlrev_b32 v17, 4, v17
    v_lshl_add_u32 v17, v16, 10, v17
    s_add_u32 s48, s47, 8192
    v_mov_b32 v3, 0x3f803f80
    buffer_load_dwordx4 v[32:35], v17, s[8:11], s47 offen offset:0
    buffer_load_dwordx4 v[36:39], v17, s[8:11], s47 offen offset:128
    buffer_load_dwordx4 v[40:43], v17, s[8:11], s47 offen offset:256
    buffer_load_dwordx4 v[44:47], v17, s[8:11], s47 offen offset:384
    buffer_load_dwordx4 v[48:51], v17, s[8:11], s47 offen offset:512
    buffer_load_dwordx4 v[52:55], v17, s[8:11], s47 offen offset:640
    buffer_load_dwordx4 v[56:59], v17, s[8:11], s47 offen offset:768
    buffer_load_dwordx4 v[60:63], v17, s[8:11], s47 offen offset:896
    buffer_load_dwordx4 v[64:67], v17, s[8:11], s48 offen offset:0
    buffer_load_dwordx4 v[68:71], v17, s[8:11], s48 offen offset:128
    buffer_load_dwordx4 v[72:75], v17, s[8:11], s48 offen offset:256
    buffer_load_dwordx4 v[76:79], v17, s[8:11], s48 offen offset:384
    buffer_load_dwordx4 v[80:83], v17, s[8:11], s48 offen offset:512
    buffer_load_dwordx4 v[84:87], v17, s[8:11], s48 offen offset:640
    buffer_load_dwordx4 v[88:91], v17, s[8:11], s48 offen offset:768
    buffer_load_dwordx4 v[92:95], v17, s[8:11], s48 offen offset:896
    buffer_load_dword v15, v166, s[20:23], 0 offen sc0 sc1
    v_mov_b32 v96, 0
    v_mov_b32 v97, 0
    v_mov_b32 v98, 0
    v_mov_b32 v99, 0
    s_waitcnt vmcnt(16)
    v_dot2c_f32_bf16 v96, v32, v3
    v_dot2c_f32_bf16 v97, v32, v32
    v_dot2c_f32_bf16 v96, v33, v3
    v_dot2c_f32_bf16 v97, v33, v33
    v_dot2c_f32_bf16 v96, v34, v3
    v_dot2c_f32_bf16 v97, v34, v34
    v_dot2c_f32_bf16 v96, v35, v3
    v_dot2c_f32_bf16 v97, v35, v35
    s_waitcnt vmcnt(15)
    v_dot2c_f32_bf16 v96, v36, v3
    v_dot2c_f32_bf16 v97, v36, v36
    v_dot2c_f32_bf16 v96, v37, v3
    v_dot2c_f32_bf16 v97, v37, v37
    v_dot2c_f32_bf16 v96, v38, v3
    v_dot2c_f32_bf16 v97, v38, v38
    v_dot2c_f32_bf16 v96, v39, v3
    v_dot2c_f32_bf16 v97, v39, v39
    s_waitcnt vmcnt(14)
    v_dot2c_f32_bf16 v96, v40, v3
    v_dot2c_f32_bf16 v97, v40, v40
    v_dot2c_f32_bf16 v96, v41, v3
    v_dot2c_f32_bf16 v97, v41, v41
    v_dot2c_f32_bf16 v96, v42, v3
    v_dot2c_f32_bf16 v97, v42, v42
    v_dot2c_f32_bf16 v96, v43, v3
    v_dot2c_f32_bf16 v97, v43, v43
    s_waitcnt vmcnt(13)
    v_dot2c_f32_bf16 v96, v44, v3
    v_dot2c_f32_bf16 v97, v44, v44
    v_dot2c_f32_bf16 v96, v45, v3
    v_dot2c_f32_bf16 v97, v45, v45
    v_dot2c_f32_bf16 v96, v46, v3
    v_dot2c_f32_bf16 v97, v46, v46
    v_dot2c_f32_bf16 v96, v47, v3
    v_dot2c_f32_bf16 v97, v47, v47
    s_waitcnt vmcnt(12)
    v_dot2c_f32_bf16 v96, v48, v3
    v_dot2c_f32_bf16 v97, v48, v48
    v_dot2c_f32_bf16 v96, v49, v3
    v_dot2c_f32_bf16 v97, v49, v49
    v_dot2c_f32_bf16 v96, v50, v3
    v_dot2c_f32_bf16 v97, v50, v50
    v_dot2c_f32_bf16 v96, v51, v3
    v_dot2c_f32_bf16 v97, v51, v51
    s_waitcnt vmcnt(11)
    v_dot2c_f32_bf16 v96, v52, v3
    v_dot2c_f32_bf16 v97, v52, v52
    v_dot2c_f32_bf16 v96, v53, v3
    v_dot2c_f32_bf16 v97, v53, v53
    v_dot2c_f32_bf16 v96, v54, v3
    v_dot2c_f32_bf16 v97, v54, v54
    v_dot2c_f32_bf16 v96, v55, v3
    v_dot2c_f32_bf16 v97, v55, v55
    s_waitcnt vmcnt(10)
    v_dot2c_f32_bf16 v96, v56, v3
    v_dot2c_f32_bf16 v97, v56, v56
    v_dot2c_f32_bf16 v96, v57, v3
    v_dot2c_f32_bf16 v97, v57, v57
    v_dot2c_f32_bf16 v96, v58, v3
    v_dot2c_f32_bf16 v97, v58, v58
    v_dot2c_f32_bf16 v96, v59, v3
    v_dot2c_f32_bf16 v97, v59, v59
    s_waitcnt vmcnt(9)
    v_dot2c_f32_bf16 v96, v60, v3
    v_dot2c_f32_bf16 v97, v60, v60
    v_dot2c_f32_bf16 v96, v61, v3
    v_dot2c_f32_bf16 v97, v61, v61
    v_dot2c_f32_bf16 v96, v62, v3
    v_dot2c_f32_bf16 v97, v62, v62
    v_dot2c_f32_bf16 v96, v63, v3
    v_dot2c_f32_bf16 v97, v63, v63
    s_waitcnt vmcnt(8)
    v_dot2c_f32_bf16 v98, v64, v3
    v_dot2c_f32_bf16 v99, v64, v64
    v_dot2c_f32_bf16 v98, v65, v3
    v_dot2c_f32_bf16 v99, v65, v65
    v_dot2c_f32_bf16 v98, v66, v3
    v_dot2c_f32_bf16 v99, v66, v66
    v_dot2c_f32_bf16 v98, v67, v3
    v_dot2c_f32_bf16 v99, v67, v67
    s_waitcnt vmcnt(7)
    v_dot2c_f32_bf16 v98, v68, v3
    v_dot2c_f32_bf16 v99, v68, v68
    v_dot2c_f32_bf16 v98, v69, v3
    v_dot2c_f32_bf16 v99, v69, v69
    v_dot2c_f32_bf16 v98, v70, v3
    v_dot2c_f32_bf16 v99, v70, v70
    v_dot2c_f32_bf16 v98, v71, v3
    v_dot2c_f32_bf16 v99, v71, v71
    s_waitcnt vmcnt(6)
    v_dot2c_f32_bf16 v98, v72, v3
    v_dot2c_f32_bf16 v99, v72, v72
    v_dot2c_f32_bf16 v98, v73, v3
    v_dot2c_f32_bf16 v99, v73, v73
    v_dot2c_f32_bf16 v98, v74, v3
    v_dot2c_f32_bf16 v99, v74, v74
    v_dot2c_f32_bf16 v98, v75, v3
    v_dot2c_f32_bf16 v99, v75, v75
    s_waitcnt vmcnt(5)
    v_dot2c_f32_bf16 v98, v76, v3
    v_dot2c_f32_bf16 v99, v76, v76
    v_dot2c_f32_bf16 v98, v77, v3
    v_dot2c_f32_bf16 v99, v77, v77
    v_dot2c_f32_bf16 v98, v78, v3
    v_dot2c_f32_bf16 v99, v78, v78
    v_dot2c_f32_bf16 v98, v79, v3
    v_dot2c_f32_bf16 v99, v79, v79
    s_waitcnt vmcnt(4)
    v_dot2c_f32_bf16 v98, v80, v3
    v_dot2c_f32_bf16 v99, v80, v80
    v_dot2c_f32_bf16 v98, v81, v3
    v_dot2c_f32_bf16 v99, v81, v81
    v_dot2c_f32_bf16 v98, v82, v3
    v_dot2c_f32_bf16 v99, v82, v82
    v_dot2c_f32_bf16 v98, v83, v3
    v_dot2c_f32_bf16 v99, v83, v83
    s_waitcnt vmcnt(3)
    v_dot2c_f32_bf16 v98, v84, v3
    v_dot2c_f32_bf16 v99, v84, v84
    v_dot2c_f32_bf16 v98, v85, v3
    v_dot2c_f32_bf16 v99, v85, v85
    v_dot2c_f32_bf16 v98, v86, v3
    v_dot2c_f32_bf16 v99, v86, v86
    v_dot2c_f32_bf16 v98, v87, v3
    v_dot2c_f32_bf16 v99, v87, v87
    s_waitcnt vmcnt(2)
    v_dot2c_f32_bf16 v98, v88, v3
    v_dot2c_f32_bf16 v99, v88, v88
    v_dot2c_f32_bf16 v98, v89, v3
    v_dot2c_f32_bf16 v99, v89, v89
    v_dot2c_f32_bf16 v98, v90, v3
    v_dot2c_f32_bf16 v99, v90, v90
    v_dot2c_f32_bf16 v98, v91, v3
    v_dot2c_f32_bf16 v99, v91, v91
    s_waitcnt vmcnt(1)
    v_dot2c_f32_bf16 v98, v92, v3
    v_dot2c_f32_bf16 v99, v92, v92
    v_dot2c_f32_bf16 v98, v93, v3
    v_dot2c_f32_bf16 v99, v93, v93
    v_dot2c_f32_bf16 v98, v94, v3
    v_dot2c_f32_bf16 v99, v94, v94
    v_dot2c_f32_bf16 v98, v95, v3
    v_dot2c_f32_bf16 v99, v95, v95
    v_add_f32_dpp v96, v96, v96 quad_perm:[1,0,3,2] row_mask:0xf bank_mask:0xf
    v_add_f32_dpp v97, v97, v97 quad_perm:[1,0,3,2] row_mask:0xf bank_mask:0xf
    v_add_f32_dpp v98, v98, v98 quad_perm:[1,0,3,2] row_mask:0xf bank_mask:0xf
    v_add_f32_dpp v99, v99, v99 quad_perm:[1,0,3,2] row_mask:0xf bank_mask:0xf
    v_add_f32_dpp v96, v96, v96 quad_perm:[2,3,0,1] row_mask:0xf bank_mask:0xf
    v_add_f32_dpp v97, v97, v97 quad_perm:[2,3,0,1] row_mask:0xf bank_mask:0xf
    v_add_f32_dpp v98, v98, v98 quad_perm:[2,3,0,1] row_mask:0xf bank_mask:0xf
    v_add_f32_dpp v99, v99, v99 quad_perm:[2,3,0,1] row_mask:0xf bank_mask:0xf
    v_add_f32_dpp v96, v96, v96 row_half_mirror row_mask:0xf bank_mask:0xf
    v_add_f32_dpp v97, v97, v97 row_half_mirror row_mask:0xf bank_mask:0xf
    v_add_f32_dpp v98, v98, v98 row_half_mirror row_mask:0xf bank_mask:0xf
    v_add_f32_dpp v99, v99, v99 row_half_mirror row_mask:0xf bank_mask:0xf
    v_and_b32 v18, 1, v1
    v_cmp_eq_u32 vcc, 1, v18
    s_nop 1
    v_cndmask_b32 v96, v96, v98, vcc
    v_cndmask_b32 v97, v97, v99, vcc
    v_mul_f32 v96, 0x3b000000, v96
    v_mul_f32 v97, 0x3b000000, v97
    v_fma_f32 v97, -v96, v96, v97
    v_max_f32 v97, 0, v97
    v_add_f32 v97, 0x3727c5ac, v97
    v_rsq_f32 v32, v97
    s_nop 0
    v_mul_f32 v34, v32, v96
    v_lshl_add_u32 v16, v18, 3, v16
    v_lshlrev_b32 v16, 4, v16
    s_branch fz_kernel_tagchk18
fz_kernel_tagpoll16:
    buffer_load_dword v15, v166, s[20:23], 0 offen sc0 sc1
fz_kernel_tagchk18:
    s_waitcnt vmcnt(0)
    v_readfirstlane_b32 s40, v15
    s_nop 0
    s_cmp_eq_u32 s40, 0
    s_cbranch_scc1 fz_kernel_tagno19
    s_sub_u32 s53, s54, s40
    s_add_u32 s53, s53, 100000
    s_cmp_lt_u32 s53, 102000
    s_cbranch_scc1 fz_kernel_tagok17
    s_cmp_lt_u32 s61, 197000
    s_cbranch_scc1 fz_kernel_tagok17
fz_kernel_tagno19:
    s_sleep 2
    s_sub_u32 s61, s61, 1
    s_cbranch_scc0 fz_kernel_tagpoll16
    s_mov_b32 s61, 0
fz_kernel_tagok17:
    v_mov_b32 v33, v15
    v_mov_b32 v35, v15
    s_lshl_b32 s47, s46, 8
    s_add_u32 s47, s47, 20971520
    s_mov_b32 exec_lo, 0x03030303
    s_mov_b32 exec_hi, 0x03030303
    buffer_store_dwordx4 v[32:35], v16, s[4:7], s47 offen sc0 sc1
    s_mov_b64 exec, -1
    s_setprio 0
k1_hcol:
    s_bfe_u32 s45, s2, 0x20001
    s_lshl_b32 s45, s45, 2
    s_lshr_b32 s44, s2, 3
    s_add_u32 s45, s45, s44
    s_cmp_ge_u32 s45, 14
    s_cbranch_scc1 k1_hpre
    s_and_b32 s44, s2, 1
    s_mul_i32 s43, s44, 7
    s_add_u32 s41, s45, s43
    s_add_u32 s40, s41, s43
    s_min_u32 s40, s40, 23
    s_cmp_lt_u32 s45, 7
    s_cselect_b32 s42, 14, -7
    s_add_u32 s41, s41, s42
    s_add_u32 s37, s41, 24
    s_lshl_b32 s41, s41, 7
    s_lshl_b32 s42, s40, 7
    s_lshl_b32 s44, s24, 6
    s_sub_u32 s45, s24, 8
    s_lshl_b32 s45, s45, 7
    s_cmp_lt_u32 s24, 8
    s_cselect_b32 s37, s37, s40
    s_cselect_b32 s41, s41, s42
    s_cselect_b32 s44, s44, s45
    s_cselect_b32 s43, 512, 0
    s_cselect_b32 s12, s16, s12
    s_cselect_b32 s13, s17, s13
    s_cselect_b32 s14, s18, s14
    s_add_u32 s43, s43, 3072
    v_lshrrev_b32 v16, 3, v1
    v_add_u32 v16, s44, v16
    v_mul_lo_u32 v16, v16, s43
    v_and_b32 v17, 7, v1
    v_lshl_add_u32 v16, v17, 4, v16
    s_lshl_b32 s43, s43, 3
    buffer_load_dwordx4 v[32:35], v16, s[12:15], s41 offen
    s_add_u32 s41, s41, s43
    buffer_load_dwordx4 v[36:39], v16, s[12:15], s41 offen
    s_add_u32 s41, s41, s43
    buffer_load_dwordx4 v[40:43], v16, s[12:15], s41 offen
    s_add_u32 s41, s41, s43
    buffer_load_dwordx4 v[44:47], v16, s[12:15], s41 offen
    s_add_u32 s41, s41, s43
    buffer_load_dwordx4 v[48:51], v16, s[12:15], s41 offen
    s_add_u32 s41, s41, s43
    buffer_load_dwordx4 v[52:55], v16, s[12:15], s41 offen
    s_add_u32 s41, s41, s43
    buffer_load_dwordx4 v[56:59], v16, s[12:15], s41 offen
    s_add_u32 s41, s41, s43
    buffer_load_dwordx4 v[60:63], v16, s[12:15], s41 offen
    s_add_u32 s41, s41, s43
    s_cmp_ge_u32 s24, 8
    s_cbranch_scc1 k1_hq
    s_setprio 2
    buffer_load_dword v24, v166, s[20:23], 0 offen sc0 sc1
    s_waitcnt vmcnt(8)
    v_lshlrev_b32 v96, 16, v32
    v_and_b32 v97, 0xffff0000, v32
    v_lshlrev_b32 v98, 16, v33
    v_and_b32 v99, 0xffff0000, v33
    v_lshlrev_b32 v100, 16, v34
    v_and_b32 v101, 0xffff0000, v34
    v_lshlrev_b32 v102, 16, v35
    v_and_b32 v103, 0xffff0000, v35
    s_waitcnt vmcnt(7)
    v_lshlrev_b32 v18, 16, v36
    v_and_b32 v19, 0xffff0000, v36
    v_pk_add_f32 v[96:97], v[96:97], v[18:19]
    v_lshlrev_b32 v18, 16, v37
    v_and_b32 v19, 0xffff0000, v37
    v_pk_add_f32 v[98:99], v[98:99], v[18:19]
    v_lshlrev_b32 v18, 16, v38
    v_and_b32 v19, 0xffff0000, v38
    v_pk_add_f32 v[100:101], v[100:101], v[18:19]
    v_lshlrev_b32 v18, 16, v39
    v_and_b32 v19, 0xffff0000, v39
    v_pk_add_f32 v[102:103], v[102:103], v[18:19]
    s_waitcnt vmcnt(6)
    v_lshlrev_b32 v18, 16, v40
    v_and_b32 v19, 0xffff0000, v40
    v_pk_add_f32 v[96:97], v[96:97], v[18:19]
    v_lshlrev_b32 v18, 16, v41
    v_and_b32 v19, 0xffff0000, v41
    v_pk_add_f32 v[98:99], v[98:99], v[18:19]
    v_lshlrev_b32 v18, 16, v42
    v_and_b32 v19, 0xffff0000, v42
    v_pk_add_f32 v[100:101], v[100:101], v[18:19]
    v_lshlrev_b32 v18, 16, v43
    v_and_b32 v19, 0xffff0000, v43
    v_pk_add_f32 v[102:103], v[102:103], v[18:19]
    s_waitcnt vmcnt(5)
    v_lshlrev_b32 v18, 16, v44
    v_and_b32 v19, 0xffff0000, v44
    v_pk_add_f32 v[96:97], v[96:97], v[18:19]
    v_lshlrev_b32 v18, 16, v45
    v_and_b32 v19, 0xffff0000, v45
    v_pk_add_f32 v[98:99], v[98:99], v[18:19]
    v_lshlrev_b32 v18, 16, v46
    v_and_b32 v19, 0xffff0000, v46
    v_pk_add_f32 v[100:101], v[100:101], v[18:19]
    v_lshlrev_b32 v18, 16, v47
    v_and_b32 v19, 0xffff0000, v47
    v_pk_add_f32 v[102:103], v[102:103], v[18:19]
    s_waitcnt vmcnt(4)
    v_lshlrev_b32 v18, 16, v48
    v_and_b32 v19, 0xffff0000, v48
    v_pk_add_f32 v[96:97], v[96:97], v[18:19]
    v_lshlrev_b32 v18, 16, v49
    v_and_b32 v19, 0xffff0000, v49
    v_pk_add_f32 v[98:99], v[98:99], v[18:19]
    v_lshlrev_b32 v18, 16, v50
    v_and_b32 v19, 0xffff0000, v50
    v_pk_add_f32 v[100:101], v[100:101], v[18:19]
    v_lshlrev_b32 v18, 16, v51
    v_and_b32 v19, 0xffff0000, v51
    v_pk_add_f32 v[102:103], v[102:103], v[18:19]
    s_waitcnt vmcnt(3)
    v_lshlrev_b32 v18, 16, v52
    v_and_b32 v19, 0xffff0000, v52
    v_pk_add_f32 v[96:97], v[96:97], v[18:19]
    v_lshlrev_b32 v18, 16, v53
    v_and_b32 v19, 0xffff0000, v53
    v_pk_add_f32 v[98:99], v[98:99], v[18:19]
    v_lshlrev_b32 v18, 16, v54
    v_and_b32 v19, 0xffff0000, v54
    v_pk_add_f32 v[100:101], v[100:101], v[18:19]
    v_lshlrev_b32 v18, 16, v55
    v_and_b32 v19, 0xffff0000, v55
    v_pk_add_f32 v[102:103], v[102:103], v[18:19]
    s_waitcnt vmcnt(2)
    v_lshlrev_b32 v18, 16, v56
    v_and_b32 v19, 0xffff0000, v56
    v_pk_add_f32 v[96:97], v[96:97], v[18:19]
    v_lshlrev_b32 v18, 16, v57
    v_and_b32 v19, 0xffff0000, v57
    v_pk_add_f32 v[98:99], v[98:99], v[18:19]
    v_lshlrev_b32 v18, 16, v58
    v_and_b32 v19, 0xffff0000, v58
    v_pk_add_f32 v[100:101], v[100:101], v[18:19]
    v_lshlrev_b32 v18, 16, v59
    v_and_b32 v19, 0xffff0000, v59
    v_pk_add_f32 v[102:103], v[102:103], v[18:19]
    s_waitcnt vmcnt(1)
    v_lshlrev_b32 v18, 16, v60
    v_and_b32 v19, 0xffff0000, v60
    v_pk_add_f32 v[96:97], v[96:97], v[18:19]
    v_lshlrev_b32 v18, 16, v61
    v_and_b32 v19, 0xffff0000, v61
    v_pk_add_f32 v[98:99], v[98:99], v[18:19]
    v_lshlrev_b32 v18, 16, v62
    v_and_b32 v19, 0xffff0000, v62
    v_pk_add_f32 v[100:101], v[100:101], v[18:19]
    v_lshlrev_b32 v18, 16, v63
    v_and_b32 v19, 0xffff0000, v63
    v_pk_add_f32 v[102:103], v[102:103], v[18:19]
    v_add_f32_dpp v96, v96, v96 row_ror:8 row_mask:0xf bank_mask:0xf
    v_add_f32_dpp v97, v97, v97 row_ror:8 row_mask:0xf bank_mask:0xf
    v_add_f32_dpp v98, v98, v98 row_ror:8 row_mask:0xf bank_mask:0xf
    v_add_f32_dpp v99, v99, v99 row_ror:8 row_mask:0xf bank_mask:0xf
    v_add_f32_dpp v100, v100, v100 row_ror:8 row_mask:0xf bank_mask:0xf
    v_add_f32_dpp v101, v101, v101 row_ror:8 row_mask:0xf bank_mask:0xf
    v_add_f32_dpp v102, v102, v102 row_ror:8 row_mask:0xf bank_mask:0xf
    v_add_f32_dpp v103, v103, v103 row_ror:8 row_mask:0xf bank_mask:0xf
    v_mov_b32 v104, v96
    v_mov_b32 v105, v97
    v_mov_b32 v106, v98
    v_mov_b32 v107, v99
    v_mov_b32 v108, v100
    v_mov_b32 v109, v101
    v_mov_b32 v110, v102
    v_mov_b32 v111, v103
    v_permlane16_swap_b32 v96, v104
    v_permlane16_swap_b32 v97, v105
    v_permlane16_swap_b32 v98, v106
    v_permlane16_swap_b32 v99, v107
    v_permlane16_swap_b32 v100, v108
    v_permlane16_swap_b32 v101, v109
    v_permlane16_swap_b32 v102, v110
    v_permlane16_swap_b32 v103, v111
    v_add_f32 v96, v96, v104
    v_add_f32 v97, v97, v105
    v_add_f32 v98, v98, v106
    v_add_f32 v99, v99, v107
    v_add_f32 v100, v100, v108
    v_add_f32 v101, v101, v109
    v_add_f32 v102, v102, v110
    v_add_f32 v103, v103, v111
    v_mov_b32 v104, v96
    v_mov_b32 v105, v97
    v_mov_b32 v106, v98
    v_mov_b32 v107, v99
    v_mov_b32 v108, v100
    v_mov_b32 v109, v101
    v_mov_b32 v110, v102
    v_mov_b32 v111, v103
    v_permlane32_swap_b32 v96, v104
    v_permlane32_swap_b32 v97, v105
    v_permlane32_swap_b32 v98, v106
    v_permlane32_swap_b32 v99, v107
    v_permlane32_swap_b32 v100, v108
    v_permlane32_swap_b32 v101, v109
    v_permlane32_swap_b32 v102, v110
    v_permlane32_swap_b32 v103, v111
    v_add_f32 v96, v96, v104
    v_add_f32 v97, v97, v105
    v_add_f32 v98, v98, v106
    v_add_f32 v99, v99, v107
    v_add_f32 v100, v100, v108
    v_add_f32 v101, v101, v109
    v_add_f32 v102, v102, v110
    v_add_f32 v103, v103, v111
    s_lshl_b32 s40, s24, 8
    v_lshlrev_b32 v16, 5, v17
    v_add_u32 v16, s40, v16
    ds_write_b128 v16, v[96:99]
    ds_write_b128 v16, v[100:103] offset:16
    s_waitcnt lgkmcnt(0)
    s_barrier
    s_cmp_lg_u32 s24, 0
    s_cbranch_scc1 k1_hz
    v_cmp_eq_u32 vcc, 0, v15
    s_waitcnt vmcnt(0)
    s_nop 0
    v_cndmask_b32 v15, v15, v24, vcc
    s_lshl_b32 s40, s24, 8
    v_lshlrev_b32 v16, 2, v1
    v_add_u32 v16, s40, v16
    ds_read_b32 v96, v16 offset:0
    ds_read_b32 v97, v16 offset:256
    ds_read_b32 v98, v16 offset:512
    ds_read_b32 v99, v16 offset:768
    ds_read_b32 v100, v16 offset:1024
    ds_read_b32 v101, v16 offset:1280
    ds_read_b32 v102, v16 offset:1536
    ds_read_b32 v103, v16 offset:1792
    s_branch fz_kernel_tagchk22
fz_kernel_tagpoll20:
    buffer_load_dword v15, v166, s[20:23], 0 offen sc0 sc1
fz_kernel_tagchk22:
    s_waitcnt vmcnt(0)
    v_readfirstlane_b32 s40, v15
    s_nop 0
    s_cmp_eq_u32 s40, 0
    s_cbranch_scc1 fz_kernel_tagno23
    s_sub_u32 s53, s54, s40
    s_add_u32 s53, s53, 100000
    s_cmp_lt_u32 s53, 102000
    s_cbranch_scc1 fz_kernel_tagok21
    s_cmp_lt_u32 s61, 197000
    s_cbranch_scc1 fz_kernel_tagok21
fz_kernel_tagno23:
    s_sleep 2
    s_sub_u32 s61, s61, 1
    s_cbranch_scc0 fz_kernel_tagpoll20
    s_mov_b32 s61, 0
fz_kernel_tagok21:
    s_waitcnt lgkmcnt(6)
    v_add_f32 v96, v96, v97
    s_waitcnt lgkmcnt(5)
    v_add_f32 v96, v96, v98
    s_waitcnt lgkmcnt(4)
    v_add_f32 v96, v96, v99
    s_waitcnt lgkmcnt(3)
    v_add_f32 v96, v96, v100
    s_waitcnt lgkmcnt(2)
    v_add_f32 v96, v96, v101
    s_waitcnt lgkmcnt(1)
    v_add_f32 v96, v96, v102
    s_waitcnt lgkmcnt(0)
    v_add_f32 v96, v96, v103
    s_lshl_b32 s40, s37, 9
    s_add_u32 s40, s40, 21037056
    v_lshlrev_b32 v16, 3, v1
    v_mov_b32 v97, v15
    buffer_store_dwordx2 v[96:97], v16, s[4:7], s40 offen sc0 sc1
k1_hz:
    s_barrier
    s_branch k1_hpre
k1_hq:
    buffer_load_dwordx4 v[64:67], v16, s[12:15], s41 offen
    s_add_u32 s41, s41, s43
    buffer_load_dwordx4 v[68:71], v16, s[12:15], s41 offen
    s_add_u32 s41, s41, s43
    buffer_load_dwordx4 v[72:75], v16, s[12:15], s41 offen
    s_add_u32 s41, s41, s43
    buffer_load_dwordx4 v[76:79], v16, s[12:15], s41 offen
    s_add_u32 s41, s41, s43
    buffer_load_dwordx4 v[80:83], v16, s[12:15], s41 offen
    s_add_u32 s41, s41, s43
    buffer_load_dwordx4 v[84:87], v16, s[12:15], s41 offen
    s_add_u32 s41, s41, s43
    buffer_load_dwordx4 v[88:91], v16, s[12:15], s41 offen
    s_add_u32 s41, s41, s43
    buffer_load_dwordx4 v[92:95], v16, s[12:15], s41 offen
    s_add_u32 s41, s41, s43
    s_barrier
    s_waitcnt vmcnt(15)
    v_lshlrev_b32 v96, 16, v32
    v_and_b32 v97, 0xffff0000, v32
    v_lshlrev_b32 v98, 16, v33
    v_and_b32 v99, 0xffff0000, v33
    v_lshlrev_b32 v100, 16, v34
    v_and_b32 v101, 0xffff0000, v34
    v_lshlrev_b32 v102, 16, v35
    v_and_b32 v103, 0xffff0000, v35
    s_waitcnt vmcnt(14)
    v_lshlrev_b32 v18, 16, v36
    v_and_b32 v19, 0xffff0000, v36
    v_pk_add_f32 v[96:97], v[96:97], v[18:19]
    v_lshlrev_b32 v18, 16, v37
    v_and_b32 v19, 0xffff0000, v37
    v_pk_add_f32 v[98:99], v[98:99], v[18:19]
    v_lshlrev_b32 v18, 16, v38
    v_and_b32 v19, 0xffff0000, v38
    v_pk_add_f32 v[100:101], v[100:101], v[18:19]
    v_lshlrev_b32 v18, 16, v39
    v_and_b32 v19, 0xffff0000, v39
    v_pk_add_f32 v[102:103], v[102:103], v[18:19]
    s_waitcnt vmcnt(13)
    v_lshlrev_b32 v18, 16, v40
    v_and_b32 v19, 0xffff0000, v40
    v_pk_add_f32 v[96:97], v[96:97], v[18:19]
    v_lshlrev_b32 v18, 16, v41
    v_and_b32 v19, 0xffff0000, v41
    v_pk_add_f32 v[98:99], v[98:99], v[18:19]
    v_lshlrev_b32 v18, 16, v42
    v_and_b32 v19, 0xffff0000, v42
    v_pk_add_f32 v[100:101], v[100:101], v[18:19]
    v_lshlrev_b32 v18, 16, v43
    v_and_b32 v19, 0xffff0000, v43
    v_pk_add_f32 v[102:103], v[102:103], v[18:19]
    s_waitcnt vmcnt(12)
    v_lshlrev_b32 v18, 16, v44
    v_and_b32 v19, 0xffff0000, v44
    v_pk_add_f32 v[96:97], v[96:97], v[18:19]
    v_lshlrev_b32 v18, 16, v45
    v_and_b32 v19, 0xffff0000, v45
    v_pk_add_f32 v[98:99], v[98:99], v[18:19]
    v_lshlrev_b32 v18, 16, v46
    v_and_b32 v19, 0xffff0000, v46
    v_pk_add_f32 v[100:101], v[100:101], v[18:19]
    v_lshlrev_b32 v18, 16, v47
    v_and_b32 v19, 0xffff0000, v47
    v_pk_add_f32 v[102:103], v[102:103], v[18:19]
    s_waitcnt vmcnt(11)
    v_lshlrev_b32 v18, 16, v48
    v_and_b32 v19, 0xffff0000, v48
    v_pk_add_f32 v[96:97], v[96:97], v[18:19]
    v_lshlrev_b32 v18, 16, v49
    v_and_b32 v19, 0xffff0000, v49
    v_pk_add_f32 v[98:99], v[98:99], v[18:19]
    v_lshlrev_b32 v18, 16, v50
    v_and_b32 v19, 0xffff0000, v50
    v_pk_add_f32 v[100:101], v[100:101], v[18:19]
    v_lshlrev_b32 v18, 16, v51
    v_and_b32 v19, 0xffff0000, v51
    v_pk_add_f32 v[102:103], v[102:103], v[18:19]
    s_waitcnt vmcnt(10)
    v_lshlrev_b32 v18, 16, v52
    v_and_b32 v19, 0xffff0000, v52
    v_pk_add_f32 v[96:97], v[96:97], v[18:19]
    v_lshlrev_b32 v18, 16, v53
    v_and_b32 v19, 0xffff0000, v53
    v_pk_add_f32 v[98:99], v[98:99], v[18:19]
    v_lshlrev_b32 v18, 16, v54
    v_and_b32 v19, 0xffff0000, v54
    v_pk_add_f32 v[100:101], v[100:101], v[18:19]
    v_lshlrev_b32 v18, 16, v55
    v_and_b32 v19, 0xffff0000, v55
    v_pk_add_f32 v[102:103], v[102:103], v[18:19]
    s_waitcnt vmcnt(9)
    v_lshlrev_b32 v18, 16, v56
    v_and_b32 v19, 0xffff0000, v56
    v_pk_add_f32 v[96:97], v[96:97], v[18:19]
    v_lshlrev_b32 v18, 16, v57
    v_and_b32 v19, 0xffff0000, v57
    v_pk_add_f32 v[98:99], v[98:99], v[18:19]
    v_lshlrev_b32 v18, 16, v58
    v_and_b32 v19, 0xffff0000, v58
    v_pk_add_f32 v[100:101], v[100:101], v[18:19]
    v_lshlrev_b32 v18, 16, v59
    v_and_b32 v19, 0xffff0000, v59
    v_pk_add_f32 v[102:103], v[102:103], v[18:19]
    s_waitcnt vmcnt(8)
    v_lshlrev_b32 v18, 16, v60
    v_and_b32 v19, 0xffff0000, v60
    v_pk_add_f32 v[96:97], v[96:97], v[18:19]
    v_lshlrev_b32 v18, 16, v61
    v_and_b32 v19, 0xffff0000, v61
    v_pk_add_f32 v[98:99], v[98:99], v[18:19]
    v_lshlrev_b32 v18, 16, v62
    v_and_b32 v19, 0xffff0000, v62
    v_pk_add_f32 v[100:101], v[100:101], v[18:19]
    v_lshlrev_b32 v18, 16, v63
    v_and_b32 v19, 0xffff0000, v63
    v_pk_add_f32 v[102:103], v[102:103], v[18:19]
    s_waitcnt vmcnt(7)
    v_lshlrev_b32 v18, 16, v64
    v_and_b32 v19, 0xffff0000, v64
    v_pk_add_f32 v[96:97], v[96:97], v[18:19]
    v_lshlrev_b32 v18, 16, v65
    v_and_b32 v19, 0xffff0000, v65
    v_pk_add_f32 v[98:99], v[98:99], v[18:19]
    v_lshlrev_b32 v18, 16, v66
    v_and_b32 v19, 0xffff0000, v66
    v_pk_add_f32 v[100:101], v[100:101], v[18:19]
    v_lshlrev_b32 v18, 16, v67
    v_and_b32 v19, 0xffff0000, v67
    v_pk_add_f32 v[102:103], v[102:103], v[18:19]
    s_waitcnt vmcnt(6)
    v_lshlrev_b32 v18, 16, v68
    v_and_b32 v19, 0xffff0000, v68
    v_pk_add_f32 v[96:97], v[96:97], v[18:19]
    v_lshlrev_b32 v18, 16, v69
    v_and_b32 v19, 0xffff0000, v69
    v_pk_add_f32 v[98:99], v[98:99], v[18:19]
    v_lshlrev_b32 v18, 16, v70
    v_and_b32 v19, 0xffff0000, v70
    v_pk_add_f32 v[100:101], v[100:101], v[18:19]
    v_lshlrev_b32 v18, 16, v71
    v_and_b32 v19, 0xffff0000, v71
    v_pk_add_f32 v[102:103], v[102:103], v[18:19]
    s_waitcnt vmcnt(5)
    v_lshlrev_b32 v18, 16, v72
    v_and_b32 v19, 0xffff0000, v72
    v_pk_add_f32 v[96:97], v[96:97], v[18:19]
    v_lshlrev_b32 v18, 16, v73
    v_and_b32 v19, 0xffff0000, v73
    v_pk_add_f32 v[98:99], v[98:99], v[18:19]
    v_lshlrev_b32 v18, 16, v74
    v_and_b32 v19, 0xffff0000, v74
    v_pk_add_f32 v[100:101], v[100:101], v[18:19]
    v_lshlrev_b32 v18, 16, v75
    v_and_b32 v19, 0xffff0000, v75
    v_pk_add_f32 v[102:103], v[102:103], v[18:19]
    s_waitcnt vmcnt(4)
    v_lshlrev_b32 v18, 16, v76
    v_and_b32 v19, 0xffff0000, v76
    v_pk_add_f32 v[96:97], v[96:97], v[18:19]
    v_lshlrev_b32 v18, 16, v77
    v_and_b32 v19, 0xffff0000, v77
    v_pk_add_f32 v[98:99], v[98:99], v[18:19]
    v_lshlrev_b32 v18, 16, v78
    v_and_b32 v19, 0xffff0000, v78
    v_pk_add_f32 v[100:101], v[100:101], v[18:19]
    v_lshlrev_b32 v18, 16, v79
    v_and_b32 v19, 0xffff0000, v79
    v_pk_add_f32 v[102:103], v[102:103], v[18:19]
    s_waitcnt vmcnt(3)
    v_lshlrev_b32 v18, 16, v80
    v_and_b32 v19, 0xffff0000, v80
    v_pk_add_f32 v[96:97], v[96:97], v[18:19]
    v_lshlrev_b32 v18, 16, v81
    v_and_b32 v19, 0xffff0000, v81
    v_pk_add_f32 v[98:99], v[98:99], v[18:19]
    v_lshlrev_b32 v18, 16, v82
    v_and_b32 v19, 0xffff0000, v82
    v_pk_add_f32 v[100:101], v[100:101], v[18:19]
    v_lshlrev_b32 v18, 16, v83
    v_and_b32 v19, 0xffff0000, v83
    v_pk_add_f32 v[102:103], v[102:103], v[18:19]
    s_waitcnt vmcnt(2)
    v_lshlrev_b32 v18, 16, v84
    v_and_b32 v19, 0xffff0000, v84
    v_pk_add_f32 v[96:97], v[96:97], v[18:19]
    v_lshlrev_b32 v18, 16, v85
    v_and_b32 v19, 0xffff0000, v85
    v_pk_add_f32 v[98:99], v[98:99], v[18:19]
    v_lshlrev_b32 v18, 16, v86
    v_and_b32 v19, 0xffff0000, v86
    v_pk_add_f32 v[100:101], v[100:101], v[18:19]
    v_lshlrev_b32 v18, 16, v87
    v_and_b32 v19, 0xffff0000, v87
    v_pk_add_f32 v[102:103], v[102:103], v[18:19]
    s_waitcnt vmcnt(1)
    v_lshlrev_b32 v18, 16, v88
    v_and_b32 v19, 0xffff0000, v88
    v_pk_add_f32 v[96:97], v[96:97], v[18:19]
    v_lshlrev_b32 v18, 16, v89
    v_and_b32 v19, 0xffff0000, v89
    v_pk_add_f32 v[98:99], v[98:99], v[18:19]
    v_lshlrev_b32 v18, 16, v90
    v_and_b32 v19, 0xffff0000, v90
    v_pk_add_f32 v[100:101], v[100:101], v[18:19]
    v_lshlrev_b32 v18, 16, v91
    v_and_b32 v19, 0xffff0000, v91
    v_pk_add_f32 v[102:103], v[102:103], v[18:19]
    s_waitcnt vmcnt(0)
    v_lshlrev_b32 v18, 16, v92
    v_and_b32 v19, 0xffff0000, v92
    v_pk_add_f32 v[96:97], v[96:97], v[18:19]
    v_lshlrev_b32 v18, 16, v93
    v_and_b32 v19, 0xffff0000, v93
    v_pk_add_f32 v[98:99], v[98:99], v[18:19]
    v_lshlrev_b32 v18, 16, v94
    v_and_b32 v19, 0xffff0000, v94
    v_pk_add_f32 v[100:101], v[100:101], v[18:19]
    v_lshlrev_b32 v18, 16, v95
    v_and_b32 v19, 0xffff0000, v95
    v_pk_add_f32 v[102:103], v[102:103], v[18:19]
    v_add_f32_dpp v96, v96, v96 row_ror:8 row_mask:0xf bank_mask:0xf
    v_add_f32_dpp v97, v97, v97 row_ror:8 row_mask:0xf bank_mask:0xf
    v_add_f32_dpp v98, v98, v98 row_ror:8 row_mask:0xf bank_mask:0xf
    v_add_f32_dpp v99, v99, v99 row_ror:8 row_mask:0xf bank_mask:0xf
    v_add_f32_dpp v100, v100, v100 row_ror:8 row_mask:0xf bank_mask:0xf
    v_add_f32_dpp v101, v101, v101 row_ror:8 row_mask:0xf bank_mask:0xf
    v_add_f32_dpp v102, v102, v102 row_ror:8 row_mask:0xf bank_mask:0xf
    v_add_f32_dpp v103, v103, v103 row_ror:8 row_mask:0xf bank_mask:0xf
    v_mov_b32 v104, v96
    v_mov_b32 v105, v97
    v_mov_b32 v106, v98
    v_mov_b32 v107, v99
    v_mov_b32 v108, v100
    v_mov_b32 v109, v101
    v_mov_b32 v110, v102
    v_mov_b32 v111, v103
    v_permlane16_swap_b32 v96, v104
    v_permlane16_swap_b32 v97, v105
    v_permlane16_swap_b32 v98, v106
    v_permlane16_swap_b32 v99, v107
    v_permlane16_swap_b32 v100, v108
    v_permlane16_swap_b32 v101, v109
    v_permlane16_swap_b32 v102, v110
    v_permlane16_swap_b32 v103, v111
    v_add_f32 v96, v96, v104
    v_add_f32 v97, v97, v105
    v_add_f32 v98, v98, v106
    v_add_f32 v99, v99, v107
    v_add_f32 v100, v100, v108
    v_add_f32 v101, v101, v109
    v_add_f32 v102, v102, v110
    v_add_f32 v103, v103, v111
    v_mov_b32 v104, v96
    v_mov_b32 v105, v97
    v_mov_b32 v106, v98
    v_mov_b32 v107, v99
    v_mov_b32 v108, v100
    v_mov_b32 v109, v101
    v_mov_b32 v110, v102
    v_mov_b32 v111, v103
    v_permlane32_swap_b32 v96, v104
    v_permlane32_swap_b32 v97, v105
    v_permlane32_swap_b32 v98, v106
    v_permlane32_swap_b32 v99, v107
    v_permlane32_swap_b32 v100, v108
    v_permlane32_swap_b32 v101, v109
    v_permlane32_swap_b32 v102, v110
    v_permlane32_swap_b32 v103, v111
    v_add_f32 v96, v96, v104
    v_add_f32 v97, v97, v105
    v_add_f32 v98, v98, v106
    v_add_f32 v99, v99, v107
    v_add_f32 v100, v100, v108
    v_add_f32 v101, v101, v109
    v_add_f32 v102, v102, v110
    v_add_f32 v103, v103, v111
    s_lshl_b32 s40, s24, 8
    v_lshlrev_b32 v16, 5, v17
    v_add_u32 v16, s40, v16
    ds_write_b128 v16, v[96:99]
    ds_write_b128 v16, v[100:103] offset:16
    s_waitcnt lgkmcnt(0)
    s_barrier
    s_cmp_lg_u32 s24, 8
    s_cbranch_scc1 k1_hpre
    s_lshl_b32 s40, s24, 8
    v_lshlrev_b32 v16, 2, v1
    v_add_u32 v16, s40, v16
    ds_read_b32 v96, v16 offset:0
    ds_read_b32 v97, v16 offset:256
    ds_read_b32 v98, v16 offset:512
    ds_read_b32 v99, v16 offset:768
    s_branch fz_kernel_tagchk26
fz_kernel_tagpoll24:
    buffer_load_dword v15, v166, s[20:23], 0 offen sc0 sc1
fz_kernel_tagchk26:
    s_waitcnt vmcnt(0)
    v_readfirstlane_b32 s40, v15
    s_nop 0
    s_cmp_eq_u32 s40, 0
    s_cbranch_scc1 fz_kernel_tagno27
    s_sub_u32 s53, s54, s40
    s_add_u32 s53, s53, 100000
    s_cmp_lt_u32 s53, 102000
    s_cbranch_scc1 fz_kernel_tagok25
    s_cmp_lt_u32 s61, 197000
    s_cbranch_scc1 fz_kernel_tagok25
fz_kernel_tagno27:
    s_sleep 2
    s_sub_u32 s61, s61, 1
    s_cbranch_scc0 fz_kernel_tagpoll24
    s_mov_b32 s61, 0
fz_kernel_tagok25:
    s_waitcnt lgkmcnt(2)
    v_add_f32 v96, v96, v97
    s_waitcnt lgkmcnt(1)
    v_add_f32 v96, v96, v98
    s_waitcnt lgkmcnt(0)
    v_add_f32 v96, v96, v99
    s_lshl_b32 s40, s37, 9
    s_add_u32 s40, s40, 21037056
    v_lshlrev_b32 v16, 3, v1
    v_mov_b32 v97, v15
    buffer_store_dwordx2 v[96:97], v16, s[4:7], s40 offen sc0 sc1
k1_hpre:
    s_cmp_lg_u32 s24, 8
    s_cbranch_scc1 k1_fin
    s_branch fz_kernel_tagchk30
fz_kernel_tagpoll28:
    buffer_load_dword v15, v166, s[20:23], 0 offen sc0 sc1
fz_kernel_tagchk30:
    s_waitcnt vmcnt(0)
    v_readfirstlane_b32 s40, v15
    s_nop 0
    s_cmp_eq_u32 s40, 0
    s_cbranch_scc1 fz_kernel_tagno31
    s_sub_u32 s53, s54, s40
    s_add_u32 s53, s53, 100000
    s_cmp_lt_u32 s53, 102000
    s_cbranch_scc1 fz_kernel_tagok29
    s_cmp_lt_u32 s61, 197000
    s_cbranch_scc1 fz_kernel_tagok29
fz_kernel_tagno31:
    s_sleep 2
    s_sub_u32 s61, s61, 1
    s_cbranch_scc0 fz_kernel_tagpoll28
    s_mov_b32 s61, 0
fz_kernel_tagok29:
    s_mov_b32 s99, s40
    v_mov_b32 v16, 147456
    ds_write_b32 v16, v15
    s_branch k1_fin
k1_fin0:
    s_waitcnt lgkmcnt(0)
    s_barrier
    s_barrier
    s_barrier
    s_barrier
    s_barrier
    s_barrier
    s_barrier
    s_barrier
k1_clb:
k1_fin:
    s_waitcnt vmcnt(0) lgkmcnt(0)
    s_barrier
    s_cmp_lg_u32 s24, 8
    s_cbranch_scc1 fz_kernel_noarr32
    s_lshl_b32 s40, s98, 6
    s_add_u32 s40, s40, 24117248
    v_mov_b32 v16, s99
    v_mov_b32 v17, 0
    s_mov_b64 exec, 1
    buffer_store_dword v16, v17, s[4:7], s40 offen sc0 sc1
    s_mov_b64 exec, -1
fz_kernel_noarr32:
    s_setprio 0
    s_load_dwordx2 s[4:5], s[0:1], 80
    s_load_dwordx2 s[8:9], s[0:1], 40
    s_load_dwordx2 s[12:13], s[0:1], 48
    v_lshrrev_b32 v4, 6, v0
    v_and_b32 v1, 63, v0
    v_readfirstlane_b32 s16, v4
    s_and_b32 s36, s2, 7
    s_lshr_b32 s21, s2, 3
    s_lshr_b32 s38, s21, 3
    s_lshl_b32 s17, s36, 2
    s_add_u32 s17, s17, s38
    s_lshl_b32 s39, s17, 16
    s_mov_b32 s6, 33554432
    s_mov_b32 s7, 0x00020000
    s_mov_b32 s10, 8388608
    s_mov_b32 s11, 0x00020000
    s_mov_b32 s14, 4096
    s_mov_b32 s15, 0x00020000
    s_mov_b32 s32, 0x0000ffff
    s_mov_b32 s33, 0x0000ffff
    v_lshlrev_b32 v2, 4, v1
    v_add_u32 v3, 61440, v2
    s_and_b32 s40, s16, 3
    s_load_dwordx2 s[68:69], s[0:1], 16
    s_load_dwordx2 s[72:73], s[0:1], 56
    s_mov_b32 s70, 524288
    s_mov_b32 s71, 0x00020000
    s_mov_b32 s74, 917504
    s_mov_b32 s75, 0x00020000
    s_lshl_b32 s96, s40, 10
    v_lshrrev_b32 v4, 3, v1
    v_and_b32 v5, 7, v1
    v_lshlrev_b32 v6, 1, v4
    v_and_b32 v6, 4, v6
    v_xor_b32 v5, v5, v6
    v_lshlrev_b32 v5, 4, v5
    v_lshl_add_u32 v5, v4, 10, v5
    s_lshr_b32 s97, s2, 3
    s_and_b32 s97, s97, 7
    s_lshl_b32 s97, s97, 7
    v_add_u32 v5, s97, v5
    s_lshl_b32 s97, s40, 13
    v_add_u32 v126, s97, v5
    s_waitcnt lgkmcnt(0)
    s_cmp_ge_u32 s16, 8
    s_cbranch_scc1 k2_gemm
    s_and_b32 s18, s21, 7
    s_lshl_b32 s18, s18, 3
    s_add_u32 s18, s18, s16
    s_lshl_b32 s41, s18, 10
    s_add_u32 s41, s41, s39
    s_add_u32 s43, s41, 0
    s_add_u32 s44, s39, 2097152
    s_waitcnt lgkmcnt(0)
    v_and_b32 v4, 27, v1
    v_mov_b32 v5, 0x3f803f80
    v_cmp_eq_u32 vcc, 16, v4
    s_nop 1
    v_cndmask_b32 v5, 0, v5, vcc
    v_mov_b32 v24, v5
    v_mov_b32 v25, v5
    v_mov_b32 v26, v5
    v_mov_b32 v27, v5
    v_mov_b32 v28, v5
    v_mov_b32 v29, v5
    v_mov_b32 v30, v5
    v_mov_b32 v31, v5
    s_lshr_b32 s41, s16, 1
    s_mul_i32 s41, s41, 30720
    s_and_b32 s42, s16, 1
    s_lshl_b32 s42, s42, 11
    s_add_u32 s41, s41, s42
    v_add_u32 v4, s41, v2
    s_not_b64 exec, s[32:33]
    ds_write_b128 v4, v[24:27] offset:26624
    ds_write_b128 v4, v[24:27] offset:27648
    s_mov_b64 exec, -1
    v_mov_b32 v80, 0
    v_mov_b32 v81, 0
    v_mov_b32 v82, 0
    v_mov_b32 v83, 0
    v_mov_b32 v84, 0
    v_mov_b32 v85, 0
    v_mov_b32 v86, 0
    v_mov_b32 v87, 0
    v_mov_b32 v88, 0
    v_mov_b32 v89, 0
    v_mov_b32 v90, 0
    v_mov_b32 v91, 0
    v_mov_b32 v92, 0
    v_mov_b32 v93, 0
    v_mov_b32 v94, 0
    v_mov_b32 v95, 0
    s_lshl_b32 s45, s18, 5
    s_add_u32 s45, s45, s17
    s_lshl_b32 s45, s45, 10
    s_add_u32 s45, s45, 14680064
    s_cmp_lg_u32 s16, 0
    s_cbranch_scc1 fz_kernel_nowait33
    v_mov_b32 v40, 147456
    ds_read_b32 v43, v40
    s_bfe_u32 s46, s2, 0x10002
    s_mul_i32 s46, s46, 7
    s_lshr_b32 s47, s21, 2
    s_add_u32 s49, s46, s47
    s_lshr_b32 s48, s17, 3
    s_add_u32 s46, s48, 4
    s_add_u32 s47, s48, 8
    s_cmp_ge_u32 s21, 28
    s_cselect_b32 s49, s46, s49
    v_mov_b32 v41, s46
    v_mov_b32 v42, s47
    v_cmp_lt_u32 vcc, 15, v1
    s_nop 1
    v_cndmask_b32 v41, v41, v42, vcc
    v_mov_b32 v42, s49
    v_cmp_lt_u32 vcc, 31, v1
    s_nop 1
    v_cndmask_b32 v41, v41, v42, vcc
    v_and_b32 v40, 15, v1
    v_lshl_add_u32 v40, v40, 4, v41
    s_and_b32 s46, s21, 7
    s_lshl_b32 s46, s46, 5
    s_add_u32 s46, s46, s48
    v_and_b32 v41, 1, v1
    v_lshlrev_b32 v41, 4, v41
    v_add_u32 v41, s46, v41
    v_cmp_lt_u32 vcc, 47, v1
    s_nop 1
    v_cndmask_b32 v40, v40, v41, vcc
    s_waitcnt lgkmcnt(0)
    v_readfirstlane_b32 s99, v43
    v_lshlrev_b32 v40, 6, v40
    s_mov_b32 s47, 600000
    s_mov_b32 s46, 24117248
fz_kernel_gpoll34:
    buffer_load_dword v41, v40, s[4:7], s46 offen sc0 sc1
    s_waitcnt vmcnt(0)
    v_cmp_ne_u32 vcc, s99, v41
    s_nop 0
    s_cmp_eq_u64 vcc, 0
    s_cbranch_scc1 fz_kernel_nowait33
    s_sleep 1
    s_sub_u32 s47, s47, 1
    s_cbranch_scc0 fz_kernel_gpoll34
fz_kernel_nowait33:
    s_barrier
    buffer_load_dwordx4 v[12:15], v2, s[4:7], s43 offen
    buffer_load_dwordx4 v[16:19], v2, s[4:7], s44 offen
    s_mov_b32 s26, 7
    s_waitcnt vmcnt(0)
    v_mfma_f32_32x32x16_bf16 v[40:55], v[16:19], v[12:15], 0
    s_waitcnt lgkmcnt(0)
    s_barrier
    ds_read_b128 v[20:23], v2 offset:24576
    ds_read_b128 v[24:27], v2 offset:26624
    ds_read_b128 v[28:31], v2 offset:27648
    s_nop 6
    v_exp_f32 v40, v40
    ds_read_b128 v[16:19], v2 offset:25600
    v_exp_f32 v41, v41
    v_exp_f32 v42, v42
    v_exp_f32 v43, v43
    ds_read_b128 v[32:35], v2 offset:28672
    v_cvt_pk_bf16_f32 v72, v40, v41
    v_exp_f32 v44, v44
    v_exp_f32 v45, v45
    ds_read_b128 v[36:39], v2 offset:29696
    v_cvt_pk_bf16_f32 v73, v42, v43
    v_exp_f32 v46, v46
    s_waitcnt lgkmcnt(5)
    v_mfma_f32_32x32x16_bf16 v[56:71], v[20:23], v[12:15], 0
    v_exp_f32 v47, v47
    v_cvt_pk_bf16_f32 v74, v44, v45
    v_exp_f32 v48, v48
    s_setprio 0
    v_cvt_pk_bf16_f32 v75, v46, v47
    v_exp_f32 v49, v49
    v_exp_f32 v50, v50
    v_exp_f32 v51, v51
    v_cvt_pk_bf16_f32 v76, v48, v49
    s_waitcnt lgkmcnt(4)
    v_mfma_f32_32x32x16_bf16 v[80:95], v[24:27], v[72:75], v[80:95]
    v_exp_f32 v52, v52
    v_exp_f32 v53, v53
    v_cvt_pk_bf16_f32 v77, v50, v51
    v_exp_f32 v54, v54
    v_exp_f32 v55, v55
    v_cvt_pk_bf16_f32 v78, v52, v53
    v_cvt_pk_bf16_f32 v79, v54, v55
    s_waitcnt lgkmcnt(0)
    s_barrier
    s_setprio 3
    v_exp_f32 v56, v56
    ds_read_b128 v[20:23], v2 offset:55296
    v_exp_f32 v57, v57
    v_mfma_f32_32x32x16_bf16 v[80:95], v[28:31], v[76:79], v[80:95]
    v_exp_f32 v58, v58
    v_exp_f32 v59, v59
    ds_read_b128 v[24:27], v2 offset:57344
    v_cvt_pk_bf16_f32 v72, v56, v57
    v_exp_f32 v60, v60
    v_exp_f32 v61, v61
    ds_read_b128 v[28:31], v2 offset:58368
    v_cvt_pk_bf16_f32 v73, v58, v59
    v_exp_f32 v62, v62
    v_mfma_f32_32x32x16_bf16 v[40:55], v[16:19], v[12:15], 0
    v_exp_f32 v63, v63
    v_cvt_pk_bf16_f32 v74, v60, v61
    v_exp_f32 v64, v64
    s_setprio 2
    v_cvt_pk_bf16_f32 v75, v62, v63
    v_exp_f32 v65, v65
    v_exp_f32 v66, v66
    v_exp_f32 v67, v67
    v_cvt_pk_bf16_f32 v76, v64, v65
    v_mfma_f32_32x32x16_bf16 v[80:95], v[32:35], v[72:75], v[80:95]
    v_exp_f32 v68, v68
    v_exp_f32 v69, v69
    v_cvt_pk_bf16_f32 v77, v66, v67
    v_exp_f32 v70, v70
    v_exp_f32 v71, v71
    v_cvt_pk_bf16_f32 v78, v68, v69
    v_cvt_pk_bf16_f32 v79, v70, v71
    s_setprio 1
    v_exp_f32 v40, v40
    ds_read_b128 v[16:19], v2 offset:56320
    v_exp_f32 v41, v41
    v_mfma_f32_32x32x16_bf16 v[80:95], v[36:39], v[76:79], v[80:95]
    v_exp_f32 v42, v42
    v_exp_f32 v43, v43
    ds_read_b128 v[32:35], v2 offset:59392
    v_cvt_pk_bf16_f32 v72, v40, v41
    v_exp_f32 v44, v44
    v_exp_f32 v45, v45
    ds_read_b128 v[36:39], v2 offset:60416
    v_cvt_pk_bf16_f32 v73, v42, v43
    v_exp_f32 v46, v46
    s_waitcnt lgkmcnt(5)
    v_mfma_f32_32x32x16_bf16 v[56:71], v[20:23], v[12:15], 0
    v_exp_f32 v47, v47
    v_cvt_pk_bf16_f32 v74, v44, v45
    v_exp_f32 v48, v48
    s_setprio 0
    v_cvt_pk_bf16_f32 v75, v46, v47
    v_exp_f32 v49, v49
    v_exp_f32 v50, v50
    v_exp_f32 v51, v51
    v_cvt_pk_bf16_f32 v76, v48, v49
    s_waitcnt lgkmcnt(4)
    v_mfma_f32_32x32x16_bf16 v[80:95], v[24:27], v[72:75], v[80:95]
    v_exp_f32 v52, v52
    v_exp_f32 v53, v53
    v_cvt_pk_bf16_f32 v77, v50, v51
    v_exp_f32 v54, v54
    v_exp_f32 v55, v55
    v_cvt_pk_bf16_f32 v78, v52, v53
    v_cvt_pk_bf16_f32 v79, v54, v55
    s_waitcnt lgkmcnt(0)
    s_barrier
    s_setprio 3
    v_exp_f32 v56, v56
    ds_read_b128 v[20:23], v3 offset:24576
    v_exp_f32 v57, v57
    v_mfma_f32_32x32x16_bf16 v[80:95], v[28:31], v[76:79], v[80:95]
    v_exp_f32 v58, v58
    v_exp_f32 v59, v59
    ds_read_b128 v[24:27], v3 offset:26624
    v_cvt_pk_bf16_f32 v72, v56, v57
    v_exp_f32 v60, v60
    v_exp_f32 v61, v61
    ds_read_b128 v[28:31], v3 offset:27648
    v_cvt_pk_bf16_f32 v73, v58, v59
    v_exp_f32 v62, v62
    v_mfma_f32_32x32x16_bf16 v[40:55], v[16:19], v[12:15], 0
    v_exp_f32 v63, v63
    v_cvt_pk_bf16_f32 v74, v60, v61
    v_exp_f32 v64, v64
    s_setprio 2
    v_cvt_pk_bf16_f32 v75, v62, v63
    v_exp_f32 v65, v65
    v_exp_f32 v66, v66
    v_exp_f32 v67, v67
    v_cvt_pk_bf16_f32 v76, v64, v65
    v_mfma_f32_32x32x16_bf16 v[80:95], v[32:35], v[72:75], v[80:95]
    v_exp_f32 v68, v68
    v_exp_f32 v69, v69
    v_cvt_pk_bf16_f32 v77, v66, v67
    v_exp_f32 v70, v70
    v_exp_f32 v71, v71
    v_cvt_pk_bf16_f32 v78, v68, v69
    v_cvt_pk_bf16_f32 v79, v70, v71
    s_setprio 1
    v_exp_f32 v40, v40
    ds_read_b128 v[16:19], v3 offset:25600
    v_exp_f32 v41, v41
    v_mfma_f32_32x32x16_bf16 v[80:95], v[36:39], v[76:79], v[80:95]
    v_exp_f32 v42, v42
    v_exp_f32 v43, v43
    ds_read_b128 v[32:35], v3 offset:28672
    v_cvt_pk_bf16_f32 v72, v40, v41
    v_exp_f32 v44, v44
    v_exp_f32 v45, v45
    ds_read_b128 v[36:39], v3 offset:29696
    v_cvt_pk_bf16_f32 v73, v42, v43
    v_exp_f32 v46, v46
    s_waitcnt lgkmcnt(5)
    v_mfma_f32_32x32x16_bf16 v[56:71], v[20:23], v[12:15], 0
    v_exp_f32 v47, v47
    v_cvt_pk_bf16_f32 v74, v44, v45
    v_exp_f32 v48, v48
    s_setprio 0
    v_cvt_pk_bf16_f32 v75, v46, v47
    v_exp_f32 v49, v49
    v_exp_f32 v50, v50
    v_exp_f32 v51, v51
    v_cvt_pk_bf16_f32 v76, v48, v49
    s_waitcnt lgkmcnt(4)
    v_mfma_f32_32x32x16_bf16 v[80:95], v[24:27], v[72:75], v[80:95]
    v_exp_f32 v52, v52
    v_exp_f32 v53, v53
    v_cvt_pk_bf16_f32 v77, v50, v51
    v_exp_f32 v54, v54
    v_exp_f32 v55, v55
    v_cvt_pk_bf16_f32 v78, v52, v53
    v_cvt_pk_bf16_f32 v79, v54, v55
    s_waitcnt lgkmcnt(0)
    s_barrier
    s_setprio 3
    v_exp_f32 v56, v56
    ds_read_b128 v[20:23], v3 offset:55296
    v_exp_f32 v57, v57
    v_mfma_f32_32x32x16_bf16 v[80:95], v[28:31], v[76:79], v[80:95]
    v_exp_f32 v58, v58
    v_exp_f32 v59, v59
    ds_read_b128 v[24:27], v3 offset:57344
    v_cvt_pk_bf16_f32 v72, v56, v57
    v_exp_f32 v60, v60
    v_exp_f32 v61, v61
    ds_read_b128 v[28:31], v3 offset:58368
    v_cvt_pk_bf16_f32 v73, v58, v59
    v_exp_f32 v62, v62
    v_mfma_f32_32x32x16_bf16 v[40:55], v[16:19], v[12:15], 0
    v_exp_f32 v63, v63
    v_cvt_pk_bf16_f32 v74, v60, v61
    v_exp_f32 v64, v64
    s_setprio 2
    v_cvt_pk_bf16_f32 v75, v62, v63
    v_exp_f32 v65, v65
    v_exp_f32 v66, v66
    v_exp_f32 v67, v67
    v_cvt_pk_bf16_f32 v76, v64, v65
    v_mfma_f32_32x32x16_bf16 v[80:95], v[32:35], v[72:75], v[80:95]
    v_exp_f32 v68, v68
    v_exp_f32 v69, v69
    v_cvt_pk_bf16_f32 v77, v66, v67
    v_exp_f32 v70, v70
    v_exp_f32 v71, v71
    v_cvt_pk_bf16_f32 v78, v68, v69
    v_cvt_pk_bf16_f32 v79, v70, v71
    s_setprio 1
    v_exp_f32 v40, v40
    ds_read_b128 v[16:19], v3 offset:56320
    v_exp_f32 v41, v41
    v_mfma_f32_32x32x16_bf16 v[80:95], v[36:39], v[76:79], v[80:95]
    v_exp_f32 v42, v42
    v_exp_f32 v43, v43
    ds_read_b128 v[32:35], v3 offset:59392
    v_cvt_pk_bf16_f32 v72, v40, v41
    v_exp_f32 v44, v44
    v_exp_f32 v45, v45
    ds_read_b128 v[36:39], v3 offset:60416
    v_cvt_pk_bf16_f32 v73, v42, v43
    v_exp_f32 v46, v46
    s_waitcnt lgkmcnt(5)
    v_mfma_f32_32x32x16_bf16 v[56:71], v[20:23], v[12:15], 0
    v_exp_f32 v47, v47
    v_cvt_pk_bf16_f32 v74, v44, v45
    v_exp_f32 v48, v48
    s_setprio 0
    v_cvt_pk_bf16_f32 v75, v46, v47
    v_exp_f32 v49, v49
    v_exp_f32 v50, v50
    v_exp_f32 v51, v51
    v_cvt_pk_bf16_f32 v76, v48, v49
    s_waitcnt lgkmcnt(4)
    v_mfma_f32_32x32x16_bf16 v[80:95], v[24:27], v[72:75], v[80:95]
    v_exp_f32 v52, v52
    v_exp_f32 v53, v53
    v_cvt_pk_bf16_f32 v77, v50, v51
    v_exp_f32 v54, v54
    v_exp_f32 v55, v55
    v_cvt_pk_bf16_f32 v78, v52, v53
    v_cvt_pk_bf16_f32 v79, v54, v55
.p2align 6
fz_kernel_aloop35:
    s_waitcnt lgkmcnt(0)
    s_barrier
    s_setprio 3
    v_exp_f32 v56, v56
    ds_read_b128 v[20:23], v2 offset:24576
    v_exp_f32 v57, v57
    v_mfma_f32_32x32x16_bf16 v[80:95], v[28:31], v[76:79], v[80:95]
    v_exp_f32 v58, v58
    v_exp_f32 v59, v59
    ds_read_b128 v[24:27], v2 offset:26624
    v_cvt_pk_bf16_f32 v72, v56, v57
    v_exp_f32 v60, v60
    v_exp_f32 v61, v61
    ds_read_b128 v[28:31], v2 offset:27648
    v_cvt_pk_bf16_f32 v73, v58, v59
    v_exp_f32 v62, v62
    v_mfma_f32_32x32x16_bf16 v[40:55], v[16:19], v[12:15], 0
    v_exp_f32 v63, v63
    v_cvt_pk_bf16_f32 v74, v60, v61
    v_exp_f32 v64, v64
    s_setprio 2
    v_cvt_pk_bf16_f32 v75, v62, v63
    v_exp_f32 v65, v65
    v_exp_f32 v66, v66
    v_exp_f32 v67, v67
    v_cvt_pk_bf16_f32 v76, v64, v65
    v_mfma_f32_32x32x16_bf16 v[80:95], v[32:35], v[72:75], v[80:95]
    v_exp_f32 v68, v68
    v_exp_f32 v69, v69
    v_cvt_pk_bf16_f32 v77, v66, v67
    v_exp_f32 v70, v70
    v_exp_f32 v71, v71
    v_cvt_pk_bf16_f32 v78, v68, v69
    v_cvt_pk_bf16_f32 v79, v70, v71
    s_setprio 1
    v_exp_f32 v40, v40
    ds_read_b128 v[16:19], v2 offset:25600
    v_exp_f32 v41, v41
    v_mfma_f32_32x32x16_bf16 v[80:95], v[36:39], v[76:79], v[80:95]
    v_exp_f32 v42, v42
    v_exp_f32 v43, v43
    ds_read_b128 v[32:35], v2 offset:28672
    v_cvt_pk_bf16_f32 v72, v40, v41
    v_exp_f32 v44, v44
    v_exp_f32 v45, v45
    ds_read_b128 v[36:39], v2 offset:29696
    v_cvt_pk_bf16_f32 v73, v42, v43
    v_exp_f32 v46, v46
    s_waitcnt lgkmcnt(5)
    v_mfma_f32_32x32x16_bf16 v[56:71], v[20:23], v[12:15], 0
    v_exp_f32 v47, v47
    v_cvt_pk_bf16_f32 v74, v44, v45
    v_exp_f32 v48, v48
    s_setprio 0
    v_cvt_pk_bf16_f32 v75, v46, v47
    v_exp_f32 v49, v49
    v_exp_f32 v50, v50
    v_exp_f32 v51, v51
    v_cvt_pk_bf16_f32 v76, v48, v49
    s_waitcnt lgkmcnt(4)
    v_mfma_f32_32x32x16_bf16 v[80:95], v[24:27], v[72:75], v[80:95]
    v_exp_f32 v52, v52
    v_exp_f32 v53, v53
    v_cvt_pk_bf16_f32 v77, v50, v51
    v_exp_f32 v54, v54
    v_exp_f32 v55, v55
    v_cvt_pk_bf16_f32 v78, v52, v53
    v_cvt_pk_bf16_f32 v79, v54, v55
    s_waitcnt lgkmcnt(0)
    s_barrier
    s_setprio 3
    v_exp_f32 v56, v56
    ds_read_b128 v[20:23], v2 offset:55296
    v_exp_f32 v57, v57
    v_mfma_f32_32x32x16_bf16 v[80:95], v[28:31], v[76:79], v[80:95]
    v_exp_f32 v58, v58
    v_exp_f32 v59, v59
    ds_read_b128 v[24:27], v2 offset:57344
    v_cvt_pk_bf16_f32 v72, v56, v57
    v_exp_f32 v60, v60
    v_exp_f32 v61, v61
    ds_read_b128 v[28:31], v2 offset:58368
    v_cvt_pk_bf16_f32 v73, v58, v59
    v_exp_f32 v62, v62
    v_mfma_f32_32x32x16_bf16 v[40:55], v[16:19], v[12:15], 0
    v_exp_f32 v63, v63
    v_cvt_pk_bf16_f32 v74, v60, v61
    v_exp_f32 v64, v64
    s_setprio 2
    v_cvt_pk_bf16_f32 v75, v62, v63
    v_exp_f32 v65, v65
    v_exp_f32 v66, v66
    v_exp_f32 v67, v67
    v_cvt_pk_bf16_f32 v76, v64, v65
    v_mfma_f32_32x32x16_bf16 v[80:95], v[32:35], v[72:75], v[80:95]
    v_exp_f32 v68, v68
    v_exp_f32 v69, v69
    v_cvt_pk_bf16_f32 v77, v66, v67
    v_exp_f32 v70, v70
    v_exp_f32 v71, v71
    v_cvt_pk_bf16_f32 v78, v68, v69
    v_cvt_pk_bf16_f32 v79, v70, v71
    s_setprio 1
    v_exp_f32 v40, v40
    ds_read_b128 v[16:19], v2 offset:56320
    v_exp_f32 v41, v41
    v_mfma_f32_32x32x16_bf16 v[80:95], v[36:39], v[76:79], v[80:95]
    v_exp_f32 v42, v42
    v_exp_f32 v43, v43
    ds_read_b128 v[32:35], v2 offset:59392
    v_cvt_pk_bf16_f32 v72, v40, v41
    v_exp_f32 v44, v44
    v_exp_f32 v45, v45
    ds_read_b128 v[36:39], v2 offset:60416
    v_cvt_pk_bf16_f32 v73, v42, v43
    v_exp_f32 v46, v46
    s_waitcnt lgkmcnt(5)
    v_mfma_f32_32x32x16_bf16 v[56:71], v[20:23], v[12:15], 0
    v_exp_f32 v47, v47
    v_cvt_pk_bf16_f32 v74, v44, v45
    v_exp_f32 v48, v48
    s_setprio 0
    v_cvt_pk_bf16_f32 v75, v46, v47
    v_exp_f32 v49, v49
    v_exp_f32 v50, v50
    v_exp_f32 v51, v51
    v_cvt_pk_bf16_f32 v76, v48, v49
    s_waitcnt lgkmcnt(4)
    v_mfma_f32_32x32x16_bf16 v[80:95], v[24:27], v[72:75], v[80:95]
    v_exp_f32 v52, v52
    v_exp_f32 v53, v53
    v_cvt_pk_bf16_f32 v77, v50, v51
    v_exp_f32 v54, v54
    v_exp_f32 v55, v55
    v_cvt_pk_bf16_f32 v78, v52, v53
    v_cvt_pk_bf16_f32 v79, v54, v55
    s_waitcnt lgkmcnt(0)
    s_barrier
    s_setprio 3
    v_exp_f32 v56, v56
    ds_read_b128 v[20:23], v3 offset:24576
    v_exp_f32 v57, v57
    v_mfma_f32_32x32x16_bf16 v[80:95], v[28:31], v[76:79], v[80:95]
    v_exp_f32 v58, v58
    v_exp_f32 v59, v59
    ds_read_b128 v[24:27], v3 offset:26624
    v_cvt_pk_bf16_f32 v72, v56, v57
    v_exp_f32 v60, v60
    v_exp_f32 v61, v61
    ds_read_b128 v[28:31], v3 offset:27648
    v_cvt_pk_bf16_f32 v73, v58, v59
    v_exp_f32 v62, v62
    v_mfma_f32_32x32x16_bf16 v[40:55], v[16:19], v[12:15], 0
    v_exp_f32 v63, v63
    v_cvt_pk_bf16_f32 v74, v60, v61
    v_exp_f32 v64, v64
    s_setprio 2
    v_cvt_pk_bf16_f32 v75, v62, v63
    v_exp_f32 v65, v65
    v_exp_f32 v66, v66
    v_exp_f32 v67, v67
    v_cvt_pk_bf16_f32 v76, v64, v65
    v_mfma_f32_32x32x16_bf16 v[80:95], v[32:35], v[72:75], v[80:95]
    v_exp_f32 v68, v68
    v_exp_f32 v69, v69
    v_cvt_pk_bf16_f32 v77, v66, v67
    v_exp_f32 v70, v70
    v_exp_f32 v71, v71
    v_cvt_pk_bf16_f32 v78, v68, v69
    v_cvt_pk_bf16_f32 v79, v70, v71
    s_setprio 1
    v_exp_f32 v40, v40
    ds_read_b128 v[16:19], v3 offset:25600
    v_exp_f32 v41, v41
    v_mfma_f32_32x32x16_bf16 v[80:95], v[36:39], v[76:79], v[80:95]
    v_exp_f32 v42, v42
    v_exp_f32 v43, v43
    ds_read_b128 v[32:35], v3 offset:28672
    v_cvt_pk_bf16_f32 v72, v40, v41
    v_exp_f32 v44, v44
    v_exp_f32 v45, v45
    ds_read_b128 v[36:39], v3 offset:29696
    v_cvt_pk_bf16_f32 v73, v42, v43
    v_exp_f32 v46, v46
    s_waitcnt lgkmcnt(5)
    v_mfma_f32_32x32x16_bf16 v[56:71], v[20:23], v[12:15], 0
    v_exp_f32 v47, v47
    v_cvt_pk_bf16_f32 v74, v44, v45
    v_exp_f32 v48, v48
    s_setprio 0
    v_cvt_pk_bf16_f32 v75, v46, v47
    v_exp_f32 v49, v49
    v_exp_f32 v50, v50
    v_exp_f32 v51, v51
    v_cvt_pk_bf16_f32 v76, v48, v49
    s_waitcnt lgkmcnt(4)
    v_mfma_f32_32x32x16_bf16 v[80:95], v[24:27], v[72:75], v[80:95]
    v_exp_f32 v52, v52
    v_exp_f32 v53, v53
    v_cvt_pk_bf16_f32 v77, v50, v51
    v_exp_f32 v54, v54
    v_exp_f32 v55, v55
    v_cvt_pk_bf16_f32 v78, v52, v53
    v_cvt_pk_bf16_f32 v79, v54, v55
    s_waitcnt lgkmcnt(0)
    s_barrier
    s_setprio 3
    v_exp_f32 v56, v56
    ds_read_b128 v[20:23], v3 offset:55296
    v_exp_f32 v57, v57
    v_mfma_f32_32x32x16_bf16 v[80:95], v[28:31], v[76:79], v[80:95]
    v_exp_f32 v58, v58
    v_exp_f32 v59, v59
    ds_read_b128 v[24:27], v3 offset:57344
    v_cvt_pk_bf16_f32 v72, v56, v57
    v_exp_f32 v60, v60
    v_exp_f32 v61, v61
    ds_read_b128 v[28:31], v3 offset:58368
    v_cvt_pk_bf16_f32 v73, v58, v59
    v_exp_f32 v62, v62
    v_mfma_f32_32x32x16_bf16 v[40:55], v[16:19], v[12:15], 0
    v_exp_f32 v63, v63
    v_cvt_pk_bf16_f32 v74, v60, v61
    v_exp_f32 v64, v64
    s_setprio 2
    v_cvt_pk_bf16_f32 v75, v62, v63
    v_exp_f32 v65, v65
    v_exp_f32 v66, v66
    v_exp_f32 v67, v67
    v_cvt_pk_bf16_f32 v76, v64, v65
    v_mfma_f32_32x32x16_bf16 v[80:95], v[32:35], v[72:75], v[80:95]
    v_exp_f32 v68, v68
    v_exp_f32 v69, v69
    v_cvt_pk_bf16_f32 v77, v66, v67
    v_exp_f32 v70, v70
    v_exp_f32 v71, v71
    v_cvt_pk_bf16_f32 v78, v68, v69
    v_cvt_pk_bf16_f32 v79, v70, v71
    s_setprio 1
    v_exp_f32 v40, v40
    ds_read_b128 v[16:19], v3 offset:56320
    v_exp_f32 v41, v41
    v_mfma_f32_32x32x16_bf16 v[80:95], v[36:39], v[76:79], v[80:95]
    v_exp_f32 v42, v42
    v_exp_f32 v43, v43
    ds_read_b128 v[32:35], v3 offset:59392
    v_cvt_pk_bf16_f32 v72, v40, v41
    v_exp_f32 v44, v44
    v_exp_f32 v45, v45
    ds_read_b128 v[36:39], v3 offset:60416
    v_cvt_pk_bf16_f32 v73, v42, v43
    v_exp_f32 v46, v46
    s_waitcnt lgkmcnt(5)
    v_mfma_f32_32x32x16_bf16 v[56:71], v[20:23], v[12:15], 0
    v_exp_f32 v47, v47
    v_cvt_pk_bf16_f32 v74, v44, v45
    v_exp_f32 v48, v48
    s_setprio 0
    v_cvt_pk_bf16_f32 v75, v46, v47
    s_sub_u32 s26, s26, 1
    s_cmp_lg_u32 s26, 0
    v_exp_f32 v49, v49
    v_exp_f32 v50, v50
    v_exp_f32 v51, v51
    v_cvt_pk_bf16_f32 v76, v48, v49
    s_waitcnt lgkmcnt(4)
    v_mfma_f32_32x32x16_bf16 v[80:95], v[24:27], v[72:75], v[80:95]
    v_exp_f32 v52, v52
    v_exp_f32 v53, v53
    v_cvt_pk_bf16_f32 v77, v50, v51
    v_exp_f32 v54, v54
    v_exp_f32 v55, v55
    v_cvt_pk_bf16_f32 v78, v52, v53
    v_cvt_pk_bf16_f32 v79, v54, v55
    s_cbranch_scc1 fz_kernel_aloop35
    s_waitcnt lgkmcnt(0)
    s_barrier
    v_exp_f32 v56, v56
    v_exp_f32 v57, v57
    v_mfma_f32_32x32x16_bf16 v[80:95], v[28:31], v[76:79], v[80:95]
    v_exp_f32 v58, v58
    v_exp_f32 v59, v59
    v_cvt_pk_bf16_f32 v72, v56, v57
    v_exp_f32 v60, v60
    v_exp_f32 v61, v61
    v_cvt_pk_bf16_f32 v73, v58, v59
    v_exp_f32 v62, v62
    v_exp_f32 v63, v63
    v_cvt_pk_bf16_f32 v74, v60, v61
    v_exp_f32 v64, v64
    v_cvt_pk_bf16_f32 v75, v62, v63
    v_exp_f32 v65, v65
    v_exp_f32 v66, v66
    v_exp_f32 v67, v67
    v_cvt_pk_bf16_f32 v76, v64, v65
    v_mfma_f32_32x32x16_bf16 v[80:95], v[32:35], v[72:75], v[80:95]
    v_exp_f32 v68, v68
    v_exp_f32 v69, v69
    v_cvt_pk_bf16_f32 v77, v66, v67
    v_exp_f32 v70, v70
    v_exp_f32 v71, v71
    v_cvt_pk_bf16_f32 v78, v68, v69
    v_cvt_pk_bf16_f32 v79, v70, v71
    s_nop 1
    v_mfma_f32_32x32x16_bf16 v[80:95], v[36:39], v[76:79], v[80:95]
    s_nop 11
    v_mul_f32 v4, 0, v80
    v_fma_f32 v4, v81, 0, v4
    v_fma_f32 v4, v82, 0, v4
    v_fma_f32 v4, v83, 0, v4
    v_fma_f32 v4, v84, 0, v4
    v_fma_f32 v4, v85, 0, v4
    v_fma_f32 v4, v86, 0, v4
    v_fma_f32 v4, v87, 0, v4
    v_add_f32 v7, v4, v88
    v_add_f32 v4, v4, v88
    v_mov_b32 v5, 0x17800000
    v_mov_b32 v6, 0x67800000
    v_cmp_ge_f32 vcc, v4, v5
    v_cmp_le_f32 s[46:47], v4, v6
    s_nop 0
    s_and_b64 vcc, vcc, s[46:47]
    v_cmp_ge_f32 s[46:47], v7, v5
    s_nop 0
    s_and_b64 vcc, vcc, s[46:47]
    v_cmp_le_f32 s[46:47], v7, v6
    s_nop 0
    s_and_b64 vcc, vcc, s[46:47]
    s_cmp_eq_u64 vcc, -1
    s_cbranch_scc1 k2_store_o
    s_add_u32 s46, s39, 2097152
    s_add_u32 s47, s39, 4194304
    v_mov_b32 v4, 0xff800000
    s_mov_b32 s26, 64
    s_mov_b32 s48, s46
k2_slow1:
    buffer_load_dwordx4 v[16:19], v2, s[4:7], s48 offen
    s_waitcnt vmcnt(0)
    v_mfma_f32_32x32x16_bf16 v[40:55], v[16:19], v[12:15], 0
    s_nop 11
    v_max3_f32 v4, v40, v41, v4
    v_max3_f32 v4, v42, v43, v4
    v_max3_f32 v4, v44, v45, v4
    v_max3_f32 v4, v46, v47, v4
    v_max3_f32 v4, v48, v49, v4
    v_max3_f32 v4, v50, v51, v4
    v_max3_f32 v4, v52, v53, v4
    v_max3_f32 v4, v54, v55, v4
    s_add_u32 s48, s48, 1024
    s_sub_u32 s26, s26, 1
    s_cmp_lg_u32 s26, 0
    s_cbranch_scc1 k2_slow1
    v_mov_b32 v5, v4
    s_nop 1
    v_permlane32_swap_b32 v4, v5
    v_max_f32 v4, v4, v5
    v_sub_f32 v4, 0, v4
    v_mov_b32 v96, v4
    v_mov_b32 v80, 0
    v_mov_b32 v97, v4
    v_mov_b32 v81, 0
    v_mov_b32 v98, v4
    v_mov_b32 v82, 0
    v_mov_b32 v99, v4
    v_mov_b32 v83, 0
    v_mov_b32 v100, v4
    v_mov_b32 v84, 0
    v_mov_b32 v101, v4
    v_mov_b32 v85, 0
    v_mov_b32 v102, v4
    v_mov_b32 v86, 0
    v_mov_b32 v103, v4
    v_mov_b32 v87, 0
    v_mov_b32 v104, v4
    v_mov_b32 v88, 0
    v_mov_b32 v105, v4
    v_mov_b32 v89, 0
    v_mov_b32 v106, v4
    v_mov_b32 v90, 0
    v_mov_b32 v107, v4
    v_mov_b32 v91, 0
    v_mov_b32 v108, v4
    v_mov_b32 v92, 0
    v_mov_b32 v109, v4
    v_mov_b32 v93, 0
    v_mov_b32 v110, v4
    v_mov_b32 v94, 0
    v_mov_b32 v111, v4
    v_mov_b32 v95, 0
    v_lshrrev_b32 v6, 5, v1
    v_and_b32 v5, 15, v1
    v_lshlrev_b32 v5, 4, v5
    v_lshl_add_u32 v5, v6, 8, v5
    s_mov_b32 s26, 64
k2_slow2:
    buffer_load_dwordx4 v[16:19], v2, s[4:7], s46 offen
    s_mov_b64 exec, s[32:33]
    buffer_load_dwordx4 v[24:27], v5, s[4:7], s47 offen
    buffer_load_dwordx4 v[28:31], v5, s[4:7], s47 offen offset:512
    s_mov_b64 exec, -1
    s_waitcnt vmcnt(2)
    v_mfma_f32_32x32x16_bf16 v[40:55], v[16:19], v[12:15], v[96:111]
    s_nop 11
    v_exp_f32 v40, v40
    v_exp_f32 v41, v41
    v_exp_f32 v42, v42
    v_exp_f32 v43, v43
    v_exp_f32 v44, v44
    v_exp_f32 v45, v45
    v_exp_f32 v46, v46
    v_exp_f32 v47, v47
    v_exp_f32 v48, v48
    v_exp_f32 v49, v49
    v_exp_f32 v50, v50
    v_exp_f32 v51, v51
    v_exp_f32 v52, v52
    v_exp_f32 v53, v53
    v_exp_f32 v54, v54
    v_exp_f32 v55, v55
    v_cvt_pk_bf16_f32 v72, v40, v41
    v_cvt_pk_bf16_f32 v73, v42, v43
    v_cvt_pk_bf16_f32 v74, v44, v45
    v_cvt_pk_bf16_f32 v75, v46, v47
    v_cvt_pk_bf16_f32 v76, v48, v49
    v_cvt_pk_bf16_f32 v77, v50, v51
    v_cvt_pk_bf16_f32 v78, v52, v53
    v_cvt_pk_bf16_f32 v79, v54, v55
    s_waitcnt vmcnt(1)
    v_mfma_f32_32x32x16_bf16 v[80:95], v[24:27], v[72:75], v[80:95]
    s_waitcnt vmcnt(0)
    v_mfma_f32_32x32x16_bf16 v[80:95], v[28:31], v[76:79], v[80:95]
    s_add_u32 s46, s46, 1024
    s_add_u32 s47, s47, 1024
    s_sub_u32 s26, s26, 1
    s_cmp_lg_u32 s26, 0
    s_cbranch_scc1 k2_slow2
k2_store_o:
    s_nop 6
    v_rcp_f32 v4, v88
    s_nop 0
    v_mul_f32 v80, v80, v4
    v_mul_f32 v81, v81, v4
    v_mul_f32 v82, v82, v4
    v_mul_f32 v83, v83, v4
    v_mul_f32 v84, v84, v4
    v_mul_f32 v85, v85, v4
    v_mul_f32 v86, v86, v4
    v_mul_f32 v87, v87, v4
    v_cvt_pk_bf16_f32 v72, v80, v81
    v_cvt_pk_bf16_f32 v73, v82, v83
    v_cvt_pk_bf16_f32 v74, v84, v85
    v_cvt_pk_bf16_f32 v75, v86, v87
    buffer_store_dwordx4 v[72:75], v2, s[4:7], s45 offen sc1
    s_branch k2_fin
k2_gemm:
    s_setprio 3
    s_sub_u32 s40, s16, 8
    s_and_b32 s19, s36, 3
    s_lshl_b32 s19, s19, 2
    s_and_b32 s38, s21, 3
    s_add_u32 s19, s19, s38
    s_lshr_b32 s20, s36, 2
    s_mul_i32 s20, s20, 7
    s_lshr_b32 s38, s21, 2
    s_add_u32 s20, s20, s38
    s_mov_b32 s34, -1
    s_mov_b32 s35, 0
    s_mov_b32 s22, 0
    s_mov_b32 s23, 0
    s_mov_b32 s24, 0
    s_lshl_b32 s27, s40, 12
    s_lshl_b32 s28, s40, 11
    s_add_u32 s28, s28, 16384
    s_lshl_b32 s29, s40, 9
    s_add_u32 s29, s29, 24576
    s_lshl_b32 s30, s40, 10
    s_add_u32 s30, s30, 26624
    s_lshl_b32 s41, s40, 9
    s_add_u32 s41, s41, s39
    s_add_u32 s42, s41, 2098176
    v_add_u32 v17, s42, v2
    v_lshrrev_b32 v4, 5, v1
    v_and_b32 v5, 15, v1
    v_lshlrev_b32 v5, 4, v5
    v_lshl_add_u32 v5, v4, 8, v5
    s_add_u32 s42, s41, 4194304
    v_add_u32 v18, s42, v5
    s_waitcnt lgkmcnt(0)
    s_cmp_ge_u32 s21, 28
    s_cbranch_scc1 k2_loader
    v_lshrrev_b32 v4, 3, v1
    s_lshl_b32 s41, s40, 5
    v_add_u32 v4, s41, v4
    v_and_b32 v5, 7, v1
    s_lshl_b32 s42, s19, 19
    v_add_u32 v6, 0, v4
    v_bfe_u32 v7, v6, 1, 3
    v_xor_b32 v7, v7, v5
    v_lshlrev_b32 v7, 4, v7
    v_lshl_add_u32 v12, v6, 12, v7
    v_add_u32 v12, s42, v12
    v_add_u32 v6, 8, v4
    v_bfe_u32 v7, v6, 1, 3
    v_xor_b32 v7, v7, v5
    v_lshlrev_b32 v7, 4, v7
    v_lshl_add_u32 v13, v6, 12, v7
    v_add_u32 v13, s42, v13
    v_add_u32 v6, 16, v4
    v_bfe_u32 v7, v6, 1, 3
    v_xor_b32 v7, v7, v5
    v_lshlrev_b32 v7, 4, v7
    v_lshl_add_u32 v14, v6, 12, v7
    v_add_u32 v14, s42, v14
    v_add_u32 v6, 24, v4
    v_bfe_u32 v7, v6, 1, 3
    v_xor_b32 v7, v7, v5
    v_lshlrev_b32 v7, 4, v7
    v_lshl_add_u32 v15, v6, 12, v7
    v_add_u32 v15, s42, v15
    s_lshr_b32 s41, s40, 1
    s_lshl_b32 s42, s20, 1
    s_add_u32 s41, s41, s42
    s_lshl_b32 s41, s41, 17
    s_and_b32 s43, s40, 1
    s_lshl_b32 s43, s43, 11
    s_add_u32 s41, s41, s43
    s_add_u32 s41, s41, 10485760
    v_add_u32 v16, s41, v2
    s_lshl_b32 s43, s19, 2
    s_add_u32 s43, s43, s40
    s_mul_i32 s44, s43, 56
    s_lshl_b32 s45, s20, 2
    s_add_u32 s44, s44, s45
    s_lshl_b32 s44, s44, 10
    s_lshl_b32 s43, s43, 6
    s_add_u32 s45, s44, 6291456
    v_and_b32 v4, 31, v1
    v_lshlrev_b32 v4, 1, v4
    buffer_load_ushort v124, v4, s[12:15], s43 offen
    s_add_u32 m0, s27, 30720
    s_nop 0
    buffer_load_dwordx4 v12, s[8:11], s22 offen lds
    s_add_u32 m0, s27, 31744
    s_nop 0
    buffer_load_dwordx4 v13, s[8:11], s22 offen lds
    s_add_u32 m0, s27, 32768
    s_nop 0
    buffer_load_dwordx4 v14, s[8:11], s22 offen lds
    s_add_u32 m0, s27, 33792
    s_nop 0
    buffer_load_dwordx4 v15, s[8:11], s22 offen lds
    s_add_u32 s22, s22, 128
    s_add_u32 m0, s27, 61440
    s_nop 0
    buffer_load_dwordx4 v12, s[8:11], s22 offen lds
    s_add_u32 m0, s27, 62464
    s_nop 0
    buffer_load_dwordx4 v13, s[8:11], s22 offen lds
    s_add_u32 m0, s27, 63488
    s_nop 0
    buffer_load_dwordx4 v14, s[8:11], s22 offen lds
    s_add_u32 m0, s27, 64512
    s_nop 0
    buffer_load_dwordx4 v15, s[8:11], s22 offen lds
    s_add_u32 s22, s22, 128
    s_add_u32 m0, s27, 92160
    s_nop 0
    buffer_load_dwordx4 v12, s[8:11], s22 offen lds
    s_add_u32 m0, s27, 93184
    s_nop 0
    buffer_load_dwordx4 v13, s[8:11], s22 offen lds
    s_add_u32 m0, s27, 94208
    s_nop 0
    buffer_load_dwordx4 v14, s[8:11], s22 offen lds
    s_add_u32 m0, s27, 95232
    s_nop 0
    buffer_load_dwordx4 v15, s[8:11], s22 offen lds
    s_add_u32 s22, s22, 128
    v_mov_b32 v8, v4
    s_mov_b32 s49, s43
    v_lshrrev_b32 v4, 5, v1
    v_and_b32 v5, 31, v1
    s_lshl_b32 s43, s40, 5
    v_add_u32 v5, s43, v5
    v_bfe_u32 v6, v5, 1, 3
    v_xor_b32 v6, v6, v4
    v_lshlrev_b32 v6, 4, v6
    v_lshl_add_u32 v20, v5, 7, v6
    v_xor_b32 v21, 32, v20
    v_xor_b32 v22, 64, v20
    v_xor_b32 v23, 96, v20
    v_add_u32 v24, 61440, v20
    v_add_u32 v25, 61440, v21
    v_add_u32 v26, 61440, v22
    v_add_u32 v27, 61440, v23
    s_waitcnt vmcnt(12)
    v_lshlrev_b32 v124, 16, v124
    v_mov_b32 v28, v124
    v_mov_b32 v29, v124
    v_mov_b32 v30, v124
    v_mov_b32 v31, v124
    v_mov_b32 v32, v124
    v_mov_b32 v33, v124
    v_mov_b32 v34, v124
    v_mov_b32 v35, v124
    v_mov_b32 v36, v124
    v_mov_b32 v37, v124
    v_mov_b32 v38, v124
    v_mov_b32 v39, v124
    v_mov_b32 v40, v124
    v_mov_b32 v41, v124
    v_mov_b32 v42, v124
    v_mov_b32 v43, v124
    v_mov_b32 v44, v124
    v_mov_b32 v45, v124
    v_mov_b32 v46, v124
    v_mov_b32 v47, v124
    v_mov_b32 v48, v124
    v_mov_b32 v49, v124
    v_mov_b32 v50, v124
    v_mov_b32 v51, v124
    v_mov_b32 v52, v124
    v_mov_b32 v53, v124
    v_mov_b32 v54, v124
    v_mov_b32 v55, v124
    v_mov_b32 v56, v124
    v_mov_b32 v57, v124
    v_mov_b32 v58, v124
    v_mov_b32 v59, v124
    v_mov_b32 v76, 0
    v_mov_b32 v77, 0
    v_mov_b32 v78, 0
    v_mov_b32 v79, 0
    v_mov_b32 v80, 0
    v_mov_b32 v81, 0
    v_mov_b32 v82, 0
    v_mov_b32 v83, 0
    v_mov_b32 v84, 0
    v_mov_b32 v85, 0
    v_mov_b32 v86, 0
    v_mov_b32 v87, 0
    v_mov_b32 v88, 0
    v_mov_b32 v89, 0
    v_mov_b32 v90, 0
    v_mov_b32 v91, 0
    v_mov_b32 v100, 0
    v_mov_b32 v101, 0
    v_mov_b32 v102, 0
    v_mov_b32 v103, 0
    v_mov_b32 v104, 0
    v_mov_b32 v105, 0
    v_mov_b32 v106, 0
    v_mov_b32 v107, 0
    s_barrier
    s_add_u32 m0, s29, 0
    s_mov_b64 exec, s[34:35]
    buffer_load_dwordx4 v17, s[4:7], s24 offen lds
    s_add_u32 m0, s30, 0
    s_mov_b64 exec, s[32:33]
    buffer_load_dwordx4 v18, s[4:7], s24 offen lds
    s_mov_b64 exec, -1
    s_add_u32 s24, s24, 2048
    s_add_u32 m0, s29, 30720
    s_mov_b64 exec, s[34:35]
    buffer_load_dwordx4 v17, s[4:7], s24 offen lds
    s_add_u32 m0, s30, 30720
    s_mov_b64 exec, s[32:33]
    buffer_load_dwordx4 v18, s[4:7], s24 offen lds
    s_mov_b64 exec, -1
    s_add_u32 s24, s24, 2048
    s_add_u32 m0, s28, 30720
    s_nop 0
    buffer_load_dwordx4 v16, s[4:7], s23 offen lds
    s_add_u32 m0, s28, 30720
    s_nop 0
    buffer_load_dwordx4 v16, s[4:7], s23 offen offset:1024 lds
    s_add_u32 s23, s23, 4096
    s_waitcnt vmcnt(4)
    s_barrier
    s_add_u32 m0, s29, 61440
    s_mov_b64 exec, s[34:35]
    buffer_load_dwordx4 v17, s[4:7], s24 offen lds
    s_add_u32 m0, s30, 61440
    s_mov_b64 exec, s[32:33]
    buffer_load_dwordx4 v18, s[4:7], s24 offen lds
    s_mov_b64 exec, -1
    s_add_u32 s24, s24, 2048
    s_add_u32 m0, s28, 61440
    s_nop 0
    buffer_load_dwordx4 v16, s[4:7], s23 offen lds
    s_add_u32 m0, s28, 61440
    s_nop 0
    buffer_load_dwordx4 v16, s[4:7], s23 offen offset:1024 lds
    s_add_u32 s23, s23, 4096
    s_add_u32 m0, s29, 92160
    s_mov_b64 exec, s[34:35]
    buffer_load_dwordx4 v17, s[4:7], s24 offen lds
    s_add_u32 m0, s30, 92160
    s_mov_b64 exec, s[32:33]
    buffer_load_dwordx4 v18, s[4:7], s24 offen lds
    s_mov_b64 exec, -1
    s_add_u32 s24, s24, 2048
    s_add_u32 m0, s28, 92160
    s_nop 0
    buffer_load_dwordx4 v16, s[4:7], s23 offen lds
    s_add_u32 m0, s28, 92160
    s_nop 0
    buffer_load_dwordx4 v16, s[4:7], s23 offen offset:1024 lds
    s_add_u32 s23, s23, 4096
    buffer_load_dwordx4 v[108:111], v2, s[4:7], s45 offen offset:0
    buffer_load_dwordx4 v[112:115], v2, s[4:7], s45 offen offset:1024
    buffer_load_dwordx4 v[116:119], v2, s[4:7], s45 offen offset:2048
    buffer_load_dwordx4 v[120:123], v2, s[4:7], s45 offen offset:3072
    s_waitcnt vmcnt(12)
    s_setprio 0
    s_mov_b32 s26, 7
.p2align 6
fz_kernel_gloop36:
    s_waitcnt vmcnt(16) lgkmcnt(0)
    s_barrier
    ds_read_b128 v[92:95], v20 offset:30720
    ds_read_b128 v[60:63], v2 offset:47104
    ds_read_b128 v[64:67], v2 offset:51200
    v_mfma_f32_32x32x16_bf16 v[28:43], v[76:79], v[100:103], v[28:43]
    s_add_u32 m0, s29, 0
    s_mov_b64 exec, s[34:35]
    buffer_load_dwordx4 v17, s[4:7], s24 offen lds
    s_add_u32 m0, s30, 0
    s_mov_b64 exec, s[32:33]
    buffer_load_dwordx4 v18, s[4:7], s24 offen lds
    s_mov_b64 exec, -1
    s_add_u32 s24, s24, 2048
    v_mfma_f32_32x32x16_bf16 v[44:59], v[80:83], v[100:103], v[44:59]
    ds_read_b128 v[96:99], v21 offset:30720
    ds_read_b128 v[68:71], v2 offset:48128
    ds_read_b128 v[72:75], v2 offset:52224
    v_mfma_f32_32x32x16_bf16 v[28:43], v[84:87], v[104:107], v[28:43]
    s_add_u32 m0, s27, 0
    s_nop 0
    buffer_load_dwordx4 v12, s[8:11], s22 offen lds
    v_mfma_f32_32x32x16_bf16 v[44:59], v[88:91], v[104:107], v[44:59]
    s_add_u32 m0, s27, 1024
    s_nop 0
    buffer_load_dwordx4 v13, s[8:11], s22 offen lds
    ds_read_b128 v[100:103], v22 offset:30720
    ds_read_b128 v[76:79], v2 offset:49152
    ds_read_b128 v[80:83], v2 offset:53248
    s_waitcnt lgkmcnt(7)
    v_mfma_f32_32x32x16_bf16 v[28:43], v[60:63], v[92:95], v[28:43]
    s_add_u32 m0, s27, 2048
    s_nop 0
    buffer_load_dwordx4 v14, s[8:11], s22 offen lds
    s_waitcnt lgkmcnt(6)
    v_mfma_f32_32x32x16_bf16 v[44:59], v[64:67], v[92:95], v[44:59]
    s_add_u32 m0, s27, 3072
    s_nop 0
    buffer_load_dwordx4 v15, s[8:11], s22 offen lds
    s_add_u32 s22, s22, 128
    ds_read_b128 v[104:107], v23 offset:30720
    ds_read_b128 v[84:87], v2 offset:50176
    ds_read_b128 v[88:91], v2 offset:54272
    s_waitcnt lgkmcnt(7)
    v_mfma_f32_32x32x16_bf16 v[28:43], v[68:71], v[96:99], v[28:43]
    s_add_u32 m0, s28, 0
    s_nop 0
    buffer_load_dwordx4 v16, s[4:7], s23 offen lds
    s_waitcnt lgkmcnt(6)
    v_mfma_f32_32x32x16_bf16 v[44:59], v[72:75], v[96:99], v[44:59]
    s_add_u32 m0, s28, 0
    s_nop 0
    buffer_load_dwordx4 v16, s[4:7], s23 offen offset:1024 lds
    s_add_u32 s23, s23, 4096
    s_waitcnt vmcnt(16) lgkmcnt(0)
    s_barrier
    ds_read_b128 v[92:95], v24 offset:0
    ds_read_b128 v[60:63], v3 offset:16384
    ds_read_b128 v[64:67], v3 offset:20480
    v_mfma_f32_32x32x16_bf16 v[28:43], v[76:79], v[100:103], v[28:43]
    s_add_u32 m0, s29, 30720
    s_mov_b64 exec, s[34:35]
    buffer_load_dwordx4 v17, s[4:7], s24 offen lds
    s_add_u32 m0, s30, 30720
    s_mov_b64 exec, s[32:33]
    buffer_load_dwordx4 v18, s[4:7], s24 offen lds
    s_mov_b64 exec, -1
    s_add_u32 s24, s24, 2048
    v_mfma_f32_32x32x16_bf16 v[44:59], v[80:83], v[100:103], v[44:59]
    ds_read_b128 v[96:99], v25 offset:0
    ds_read_b128 v[68:71], v3 offset:17408
    ds_read_b128 v[72:75], v3 offset:21504
    v_mfma_f32_32x32x16_bf16 v[28:43], v[84:87], v[104:107], v[28:43]
    s_add_u32 m0, s27, 30720
    s_nop 0
    buffer_load_dwordx4 v12, s[8:11], s22 offen lds
    v_mfma_f32_32x32x16_bf16 v[44:59], v[88:91], v[104:107], v[44:59]
    s_add_u32 m0, s27, 31744
    s_nop 0
    buffer_load_dwordx4 v13, s[8:11], s22 offen lds
    ds_read_b128 v[100:103], v26 offset:0
    ds_read_b128 v[76:79], v3 offset:18432
    ds_read_b128 v[80:83], v3 offset:22528
    s_waitcnt lgkmcnt(7)
    v_mfma_f32_32x32x16_bf16 v[28:43], v[60:63], v[92:95], v[28:43]
    s_add_u32 m0, s27, 32768
    s_nop 0
    buffer_load_dwordx4 v14, s[8:11], s22 offen lds
    s_waitcnt lgkmcnt(6)
    v_mfma_f32_32x32x16_bf16 v[44:59], v[64:67], v[92:95], v[44:59]
    s_add_u32 m0, s27, 33792
    s_nop 0
    buffer_load_dwordx4 v15, s[8:11], s22 offen lds
    s_add_u32 s22, s22, 128
    ds_read_b128 v[104:107], v27 offset:0
    ds_read_b128 v[84:87], v3 offset:19456
    ds_read_b128 v[88:91], v3 offset:23552
    s_waitcnt lgkmcnt(7)
    v_mfma_f32_32x32x16_bf16 v[28:43], v[68:71], v[96:99], v[28:43]
    s_add_u32 m0, s28, 30720
    s_nop 0
    buffer_load_dwordx4 v16, s[4:7], s23 offen lds
    s_waitcnt lgkmcnt(6)
    v_mfma_f32_32x32x16_bf16 v[44:59], v[72:75], v[96:99], v[44:59]
    s_add_u32 m0, s28, 30720
    s_nop 0
    buffer_load_dwordx4 v16, s[4:7], s23 offen offset:1024 lds
    s_add_u32 s23, s23, 4096
    s_waitcnt vmcnt(16) lgkmcnt(0)
    s_barrier
    ds_read_b128 v[92:95], v24 offset:30720
    ds_read_b128 v[60:63], v3 offset:47104
    ds_read_b128 v[64:67], v3 offset:51200
    v_mfma_f32_32x32x16_bf16 v[28:43], v[76:79], v[100:103], v[28:43]
    s_add_u32 m0, s29, 61440
    s_mov_b64 exec, s[34:35]
    buffer_load_dwordx4 v17, s[4:7], s24 offen lds
    s_add_u32 m0, s30, 61440
    s_mov_b64 exec, s[32:33]
    buffer_load_dwordx4 v18, s[4:7], s24 offen lds
    s_mov_b64 exec, -1
    s_add_u32 s24, s24, 2048
    v_mfma_f32_32x32x16_bf16 v[44:59], v[80:83], v[100:103], v[44:59]
    ds_read_b128 v[96:99], v25 offset:30720
    ds_read_b128 v[68:71], v3 offset:48128
    ds_read_b128 v[72:75], v3 offset:52224
    v_mfma_f32_32x32x16_bf16 v[28:43], v[84:87], v[104:107], v[28:43]
    s_add_u32 m0, s27, 61440
    s_nop 0
    buffer_load_dwordx4 v12, s[8:11], s22 offen lds
    v_mfma_f32_32x32x16_bf16 v[44:59], v[88:91], v[104:107], v[44:59]
    s_add_u32 m0, s27, 62464
    s_nop 0
    buffer_load_dwordx4 v13, s[8:11], s22 offen lds
    ds_read_b128 v[100:103], v26 offset:30720
    ds_read_b128 v[76:79], v3 offset:49152
    ds_read_b128 v[80:83], v3 offset:53248
    s_waitcnt lgkmcnt(7)
    v_mfma_f32_32x32x16_bf16 v[28:43], v[60:63], v[92:95], v[28:43]
    s_add_u32 m0, s27, 63488
    s_nop 0
    buffer_load_dwordx4 v14, s[8:11], s22 offen lds
    s_waitcnt lgkmcnt(6)
    v_mfma_f32_32x32x16_bf16 v[44:59], v[64:67], v[92:95], v[44:59]
    s_add_u32 m0, s27, 64512
    s_nop 0
    buffer_load_dwordx4 v15, s[8:11], s22 offen lds
    s_add_u32 s22, s22, 128
    ds_read_b128 v[104:107], v27 offset:30720
    ds_read_b128 v[84:87], v3 offset:50176
    ds_read_b128 v[88:91], v3 offset:54272
    s_waitcnt lgkmcnt(7)
    v_mfma_f32_32x32x16_bf16 v[28:43], v[68:71], v[96:99], v[28:43]
    s_add_u32 m0, s28, 61440
    s_nop 0
    buffer_load_dwordx4 v16, s[4:7], s23 offen lds
    s_waitcnt lgkmcnt(6)
    v_mfma_f32_32x32x16_bf16 v[44:59], v[72:75], v[96:99], v[44:59]
    s_add_u32 m0, s28, 61440
    s_nop 0
    buffer_load_dwordx4 v16, s[4:7], s23 offen offset:1024 lds
    s_add_u32 s23, s23, 4096
    s_waitcnt vmcnt(16) lgkmcnt(0)
    s_barrier
    ds_read_b128 v[92:95], v20 offset:0
    ds_read_b128 v[60:63], v2 offset:16384
    ds_read_b128 v[64:67], v2 offset:20480
    v_mfma_f32_32x32x16_bf16 v[28:43], v[76:79], v[100:103], v[28:43]
    s_add_u32 m0, s29, 92160
    s_mov_b64 exec, s[34:35]
    buffer_load_dwordx4 v17, s[4:7], s24 offen lds
    s_add_u32 m0, s30, 92160
    s_mov_b64 exec, s[32:33]
    buffer_load_dwordx4 v18, s[4:7], s24 offen lds
    s_mov_b64 exec, -1
    s_add_u32 s24, s24, 2048
    v_mfma_f32_32x32x16_bf16 v[44:59], v[80:83], v[100:103], v[44:59]
    ds_read_b128 v[96:99], v21 offset:0
    ds_read_b128 v[68:71], v2 offset:17408
    ds_read_b128 v[72:75], v2 offset:21504
    v_mfma_f32_32x32x16_bf16 v[28:43], v[84:87], v[104:107], v[28:43]
    s_add_u32 m0, s27, 92160
    s_nop 0
    buffer_load_dwordx4 v12, s[8:11], s22 offen lds
    v_mfma_f32_32x32x16_bf16 v[44:59], v[88:91], v[104:107], v[44:59]
    s_add_u32 m0, s27, 93184
    s_nop 0
    buffer_load_dwordx4 v13, s[8:11], s22 offen lds
    ds_read_b128 v[100:103], v22 offset:0
    ds_read_b128 v[76:79], v2 offset:18432
    ds_read_b128 v[80:83], v2 offset:22528
    s_waitcnt lgkmcnt(7)
    v_mfma_f32_32x32x16_bf16 v[28:43], v[60:63], v[92:95], v[28:43]
    s_add_u32 m0, s27, 94208
    s_nop 0
    buffer_load_dwordx4 v14, s[8:11], s22 offen lds
    s_waitcnt lgkmcnt(6)
    v_mfma_f32_32x32x16_bf16 v[44:59], v[64:67], v[92:95], v[44:59]
    s_add_u32 m0, s27, 95232
    s_nop 0
    buffer_load_dwordx4 v15, s[8:11], s22 offen lds
    s_add_u32 s22, s22, 128
    ds_read_b128 v[104:107], v23 offset:0
    ds_read_b128 v[84:87], v2 offset:19456
    ds_read_b128 v[88:91], v2 offset:23552
    s_waitcnt lgkmcnt(7)
    v_mfma_f32_32x32x16_bf16 v[28:43], v[68:71], v[96:99], v[28:43]
    s_add_u32 m0, s28, 92160
    s_nop 0
    buffer_load_dwordx4 v16, s[4:7], s23 offen lds
    s_waitcnt lgkmcnt(6)
    v_mfma_f32_32x32x16_bf16 v[44:59], v[72:75], v[96:99], v[44:59]
    s_add_u32 m0, s28, 92160
    s_nop 0
    buffer_load_dwordx4 v16, s[4:7], s23 offen offset:1024 lds
    s_add_u32 s23, s23, 4096
    s_sub_u32 s26, s26, 1
    s_cmp_lg_u32 s26, 0
    s_cbranch_scc1 fz_kernel_gloop36
    s_waitcnt vmcnt(16) lgkmcnt(0)
    s_barrier
    ds_read_b128 v[92:95], v20 offset:30720
    ds_read_b128 v[60:63], v2 offset:47104
    ds_read_b128 v[64:67], v2 offset:51200
    v_mfma_f32_32x32x16_bf16 v[28:43], v[76:79], v[100:103], v[28:43]
    s_add_u32 m0, s96, 122880
    s_mov_b32 s97, 327680
    buffer_load_dwordx4 v126, s[68:71], s97 offen lds
    s_add_u32 m0, s96, 126976
    s_mov_b32 s97, 163840
    buffer_load_dwordx4 v126, s[72:75], s97 offen lds
    s_add_u32 m0, s96, 131072
    s_mov_b32 s97, 524288
    buffer_load_dwordx4 v126, s[72:75], s97 offen lds
    s_add_u32 m0, s96, 135168
    s_mov_b32 s97, 884736
    buffer_load_dwordx4 v126, s[72:75], s97 offen lds
    s_add_u32 m0, s96, 139264
    s_mov_b32 s97, 688128
    buffer_load_dwordx4 v126, s[72:75], s97 offen lds
    s_add_u32 m0, s96, 143360
    s_mov_b32 s97, 720896
    buffer_load_dwordx4 v126, s[72:75], s97 offen lds
    s_add_u32 m0, s96, 147456
    s_mov_b32 s97, 753664
    buffer_load_dwordx4 v126, s[72:75], s97 offen lds
    s_add_u32 m0, s96, 151552
    s_mov_b32 s97, 786432
    buffer_load_dwordx4 v126, s[72:75], s97 offen lds
    s_add_u32 m0, s96, 155648
    s_mov_b32 s97, 819200
    buffer_load_dwordx4 v126, s[72:75], s97 offen lds
    s_add_u32 m0, s96, 159744
    s_mov_b32 s97, 851968
    buffer_load_dwordx4 v126, s[72:75], s97 offen lds
    v_mfma_f32_32x32x16_bf16 v[44:59], v[80:83], v[100:103], v[44:59]
    ds_read_b128 v[96:99], v21 offset:30720
    ds_read_b128 v[68:71], v2 offset:48128
    ds_read_b128 v[72:75], v2 offset:52224
    v_mfma_f32_32x32x16_bf16 v[28:43], v[84:87], v[104:107], v[28:43]
    s_add_u32 m0, s27, 0
    s_nop 0
    buffer_load_dwordx4 v12, s[8:11], s22 offen lds
    v_mfma_f32_32x32x16_bf16 v[44:59], v[88:91], v[104:107], v[44:59]
    s_add_u32 m0, s27, 1024
    s_nop 0
    buffer_load_dwordx4 v13, s[8:11], s22 offen lds
    ds_read_b128 v[100:103], v22 offset:30720
    ds_read_b128 v[76:79], v2 offset:49152
    ds_read_b128 v[80:83], v2 offset:53248
    s_waitcnt lgkmcnt(7)
    v_mfma_f32_32x32x16_bf16 v[28:43], v[60:63], v[92:95], v[28:43]
    s_add_u32 m0, s27, 2048
    s_nop 0
    buffer_load_dwordx4 v14, s[8:11], s22 offen lds
    s_waitcnt lgkmcnt(6)
    v_mfma_f32_32x32x16_bf16 v[44:59], v[64:67], v[92:95], v[44:59]
    s_add_u32 m0, s27, 3072
    s_nop 0
    buffer_load_dwordx4 v15, s[8:11], s22 offen lds
    s_add_u32 s22, s22, 128
    ds_read_b128 v[104:107], v23 offset:30720
    ds_read_b128 v[84:87], v2 offset:50176
    ds_read_b128 v[88:91], v2 offset:54272
    s_waitcnt lgkmcnt(7)
    v_mfma_f32_32x32x16_bf16 v[28:43], v[68:71], v[96:99], v[28:43]
    s_add_u32 m0, s28, 0
    s_nop 0
    buffer_load_dwordx4 v16, s[4:7], s23 offen lds
    s_waitcnt lgkmcnt(6)
    v_mfma_f32_32x32x16_bf16 v[44:59], v[72:75], v[96:99], v[44:59]
    s_add_u32 m0, s28, 0
    s_nop 0
    buffer_load_dwordx4 v16, s[4:7], s23 offen offset:1024 lds
    s_add_u32 s23, s23, 4096
    s_waitcnt vmcnt(24) lgkmcnt(0)
    s_barrier
    ds_read_b128 v[92:95], v24 offset:0
    ds_read_b128 v[60:63], v3 offset:16384
    ds_read_b128 v[64:67], v3 offset:20480
    v_mfma_f32_32x32x16_bf16 v[28:43], v[76:79], v[100:103], v[28:43]
    s_add_u32 m0, s96, 32768
    s_mov_b32 s97, 262144
    buffer_load_dwordx4 v126, s[68:71], s97 offen lds
    v_mfma_f32_32x32x16_bf16 v[44:59], v[80:83], v[100:103], v[44:59]
    ds_read_b128 v[96:99], v25 offset:0
    ds_read_b128 v[68:71], v3 offset:17408
    ds_read_b128 v[72:75], v3 offset:21504
    v_mfma_f32_32x32x16_bf16 v[28:43], v[84:87], v[104:107], v[28:43]
    s_add_u32 m0, s96, 36864
    s_mov_b32 s97, 294912
    buffer_load_dwordx4 v126, s[68:71], s97 offen lds
    v_mfma_f32_32x32x16_bf16 v[44:59], v[88:91], v[104:107], v[44:59]
    s_add_u32 m0, s96, 40960
    s_mov_b32 s97, 360448
    buffer_load_dwordx4 v126, s[68:71], s97 offen lds
    ds_read_b128 v[100:103], v26 offset:0
    ds_read_b128 v[76:79], v3 offset:18432
    ds_read_b128 v[80:83], v3 offset:22528
    s_waitcnt lgkmcnt(7)
    v_mfma_f32_32x32x16_bf16 v[28:43], v[60:63], v[92:95], v[28:43]
    s_add_u32 m0, s96, 45056
    s_mov_b32 s97, 393216
    buffer_load_dwordx4 v126, s[68:71], s97 offen lds
    s_waitcnt lgkmcnt(6)
    v_mfma_f32_32x32x16_bf16 v[44:59], v[64:67], v[92:95], v[44:59]
    s_add_u32 m0, s96, 49152
    s_mov_b32 s97, 425984
    buffer_load_dwordx4 v126, s[68:71], s97 offen lds
    ds_read_b128 v[104:107], v27 offset:0
    ds_read_b128 v[84:87], v3 offset:19456
    ds_read_b128 v[88:91], v3 offset:23552
    s_waitcnt lgkmcnt(7)
    v_mfma_f32_32x32x16_bf16 v[28:43], v[68:71], v[96:99], v[28:43]
    s_add_u32 m0, s96, 53248
    s_mov_b32 s97, 458752
    buffer_load_dwordx4 v126, s[68:71], s97 offen lds
    s_waitcnt lgkmcnt(6)
    v_mfma_f32_32x32x16_bf16 v[44:59], v[72:75], v[96:99], v[44:59]
    s_add_u32 m0, s96, 57344
    s_mov_b32 s97, 491520
    buffer_load_dwordx4 v126, s[68:71], s97 offen lds
    v_lshlrev_b32 v128, 16, v108
    v_and_b32 v129, 0xffff0000, v108
    v_lshlrev_b32 v130, 16, v109
    v_and_b32 v131, 0xffff0000, v109
    v_lshlrev_b32 v132, 16, v110
    v_and_b32 v133, 0xffff0000, v110
    v_lshlrev_b32 v134, 16, v111
    v_and_b32 v135, 0xffff0000, v111
    v_lshlrev_b32 v136, 16, v112
    v_and_b32 v137, 0xffff0000, v112
    v_lshlrev_b32 v138, 16, v113
    v_and_b32 v139, 0xffff0000, v113
    v_lshlrev_b32 v140, 16, v114
    v_and_b32 v141, 0xffff0000, v114
    v_lshlrev_b32 v142, 16, v115
    v_and_b32 v143, 0xffff0000, v115
    v_lshlrev_b32 v144, 16, v116
    v_and_b32 v145, 0xffff0000, v116
    v_lshlrev_b32 v146, 16, v117
    v_and_b32 v147, 0xffff0000, v117
    v_lshlrev_b32 v148, 16, v118
    v_and_b32 v149, 0xffff0000, v118
    v_lshlrev_b32 v150, 16, v119
    v_and_b32 v151, 0xffff0000, v119
    v_lshlrev_b32 v152, 16, v120
    v_and_b32 v153, 0xffff0000, v120
    v_lshlrev_b32 v154, 16, v121
    v_and_b32 v155, 0xffff0000, v121
    v_lshlrev_b32 v156, 16, v122
    v_and_b32 v157, 0xffff0000, v122
    v_lshlrev_b32 v158, 16, v123
    v_and_b32 v159, 0xffff0000, v123
    s_waitcnt vmcnt(23) lgkmcnt(0)
    s_barrier
    ds_read_b128 v[92:95], v24 offset:30720
    ds_read_b128 v[60:63], v3 offset:47104
    ds_read_b128 v[64:67], v3 offset:51200
    v_mfma_f32_32x32x16_bf16 v[28:43], v[76:79], v[100:103], v[28:43]
    s_add_u32 m0, s96, 61440
    s_mov_b32 s97, 0
    buffer_load_dwordx4 v126, s[72:75], s97 offen lds
    v_mfma_f32_32x32x16_bf16 v[44:59], v[80:83], v[100:103], v[44:59]
    ds_read_b128 v[96:99], v25 offset:30720
    ds_read_b128 v[68:71], v3 offset:48128
    ds_read_b128 v[72:75], v3 offset:52224
    v_mfma_f32_32x32x16_bf16 v[28:43], v[84:87], v[104:107], v[28:43]
    s_add_u32 m0, s96, 65536
    s_mov_b32 s97, 32768
    buffer_load_dwordx4 v126, s[72:75], s97 offen lds
    v_mfma_f32_32x32x16_bf16 v[44:59], v[88:91], v[104:107], v[44:59]
    s_add_u32 m0, s96, 69632
    s_mov_b32 s97, 65536
    buffer_load_dwordx4 v126, s[72:75], s97 offen lds
    ds_read_b128 v[100:103], v26 offset:30720
    ds_read_b128 v[76:79], v3 offset:49152
    ds_read_b128 v[80:83], v3 offset:53248
    s_waitcnt lgkmcnt(7)
    v_mfma_f32_32x32x16_bf16 v[28:43], v[60:63], v[92:95], v[28:43]
    s_add_u32 m0, s96, 73728
    s_mov_b32 s97, 98304
    buffer_load_dwordx4 v126, s[72:75], s97 offen lds
    s_waitcnt lgkmcnt(6)
    v_mfma_f32_32x32x16_bf16 v[44:59], v[64:67], v[92:95], v[44:59]
    s_add_u32 m0, s96, 77824
    s_mov_b32 s97, 131072
    buffer_load_dwordx4 v126, s[72:75], s97 offen lds
    ds_read_b128 v[104:107], v27 offset:30720
    ds_read_b128 v[84:87], v3 offset:50176
    ds_read_b128 v[88:91], v3 offset:54272
    s_waitcnt lgkmcnt(7)
    v_mfma_f32_32x32x16_bf16 v[28:43], v[68:71], v[96:99], v[28:43]
    s_add_u32 m0, s96, 81920
    s_mov_b32 s97, 196608
    buffer_load_dwordx4 v126, s[72:75], s97 offen lds
    s_waitcnt lgkmcnt(6)
    v_mfma_f32_32x32x16_bf16 v[44:59], v[72:75], v[96:99], v[44:59]
    s_add_u32 m0, s96, 86016
    s_mov_b32 s97, 229376
    buffer_load_dwordx4 v126, s[72:75], s97 offen lds
    s_setprio 3
    s_waitcnt vmcnt(14) lgkmcnt(0)
    s_barrier
    ds_read_b128 v[92:95], v20 offset:0
    ds_read_b128 v[60:63], v2 offset:16384
    ds_read_b128 v[64:67], v2 offset:20480
    v_mfma_f32_32x32x16_bf16 v[28:43], v[76:79], v[100:103], v[28:43]
    s_add_u32 m0, s96, 90112
    s_mov_b32 s97, 262144
    buffer_load_dwordx4 v126, s[72:75], s97 offen lds
    v_mfma_f32_32x32x16_bf16 v[44:59], v[80:83], v[100:103], v[44:59]
    ds_read_b128 v[96:99], v21 offset:0
    ds_read_b128 v[68:71], v2 offset:17408
    ds_read_b128 v[72:75], v2 offset:21504
    v_mfma_f32_32x32x16_bf16 v[28:43], v[84:87], v[104:107], v[28:43]
    s_add_u32 m0, s96, 94208
    s_mov_b32 s97, 294912
    buffer_load_dwordx4 v126, s[72:75], s97 offen lds
    v_mfma_f32_32x32x16_bf16 v[44:59], v[88:91], v[104:107], v[44:59]
    s_add_u32 m0, s96, 98304
    s_mov_b32 s97, 327680
    buffer_load_dwordx4 v126, s[72:75], s97 offen lds
    ds_read_b128 v[100:103], v22 offset:0
    ds_read_b128 v[76:79], v2 offset:18432
    ds_read_b128 v[80:83], v2 offset:22528
    s_waitcnt lgkmcnt(7)
    v_mfma_f32_32x32x16_bf16 v[28:43], v[60:63], v[92:95], v[28:43]
    s_add_u32 m0, s96, 102400
    s_mov_b32 s97, 360448
    buffer_load_dwordx4 v126, s[72:75], s97 offen lds
    s_waitcnt lgkmcnt(6)
    v_mfma_f32_32x32x16_bf16 v[44:59], v[64:67], v[92:95], v[44:59]
    s_add_u32 m0, s96, 106496
    s_mov_b32 s97, 393216
    buffer_load_dwordx4 v126, s[72:75], s97 offen lds
    ds_read_b128 v[104:107], v23 offset:0
    ds_read_b128 v[84:87], v2 offset:19456
    ds_read_b128 v[88:91], v2 offset:23552
    s_waitcnt lgkmcnt(7)
    v_mfma_f32_32x32x16_bf16 v[28:43], v[68:71], v[96:99], v[28:43]
    s_add_u32 m0, s96, 110592
    s_mov_b32 s97, 425984
    buffer_load_dwordx4 v126, s[72:75], s97 offen lds
    s_waitcnt lgkmcnt(6)
    v_mfma_f32_32x32x16_bf16 v[44:59], v[72:75], v[96:99], v[44:59]
    s_add_u32 m0, s96, 114688
    s_mov_b32 s97, 458752
    buffer_load_dwordx4 v126, s[72:75], s97 offen lds
    s_add_u32 m0, s96, 118784
    s_mov_b32 s97, 491520
    buffer_load_dwordx4 v126, s[72:75], s97 offen lds
    s_waitcnt lgkmcnt(4)
    v_mfma_f32_32x32x16_bf16 v[28:43], v[76:79], v[100:103], v[28:43]
    s_waitcnt lgkmcnt(3)
    v_mfma_f32_32x32x16_bf16 v[44:59], v[80:83], v[100:103], v[44:59]
    s_waitcnt lgkmcnt(1)
    v_mfma_f32_32x32x16_bf16 v[28:43], v[84:87], v[104:107], v[28:43]
    s_waitcnt lgkmcnt(0)
    v_mfma_f32_32x32x16_bf16 v[44:59], v[88:91], v[104:107], v[44:59]
    s_add_u32 s45, s44, 16777216
    s_nop 8
    v_pk_mul_f32 v[28:29], v[28:29], v[128:129]
    v_pk_mul_f32 v[30:31], v[30:31], v[130:131]
    v_pk_mul_f32 v[32:33], v[32:33], v[132:133]
    v_pk_mul_f32 v[34:35], v[34:35], v[134:135]
    v_pk_mul_f32 v[36:37], v[36:37], v[136:137]
    v_pk_mul_f32 v[38:39], v[38:39], v[138:139]
    v_pk_mul_f32 v[40:41], v[40:41], v[140:141]
    v_pk_mul_f32 v[42:43], v[42:43], v[142:143]
    v_pk_mul_f32 v[44:45], v[44:45], v[144:145]
    v_pk_mul_f32 v[46:47], v[46:47], v[146:147]
    v_pk_mul_f32 v[48:49], v[48:49], v[148:149]
    v_pk_mul_f32 v[50:51], v[50:51], v[150:151]
    v_pk_mul_f32 v[52:53], v[52:53], v[152:153]
    v_pk_mul_f32 v[54:55], v[54:55], v[154:155]
    v_pk_mul_f32 v[56:57], v[56:57], v[156:157]
    v_pk_mul_f32 v[58:59], v[58:59], v[158:159]
    v_cvt_pk_bf16_f32 v108, v28, v29
    v_cvt_pk_bf16_f32 v109, v30, v31
    v_cvt_pk_bf16_f32 v110, v32, v33
    v_cvt_pk_bf16_f32 v111, v34, v35
    buffer_store_dwordx4 v[108:111], v2, s[4:7], s45 offen offset:0 sc1
    v_cvt_pk_bf16_f32 v112, v36, v37
    v_cvt_pk_bf16_f32 v113, v38, v39
    v_cvt_pk_bf16_f32 v114, v40, v41
    v_cvt_pk_bf16_f32 v115, v42, v43
    buffer_store_dwordx4 v[112:115], v2, s[4:7], s45 offen offset:1024 sc1
    v_cvt_pk_bf16_f32 v116, v44, v45
    v_cvt_pk_bf16_f32 v117, v46, v47
    v_cvt_pk_bf16_f32 v118, v48, v49
    v_cvt_pk_bf16_f32 v119, v50, v51
    buffer_store_dwordx4 v[116:119], v2, s[4:7], s45 offen offset:2048 sc1
    v_cvt_pk_bf16_f32 v120, v52, v53
    v_cvt_pk_bf16_f32 v121, v54, v55
    v_cvt_pk_bf16_f32 v122, v56, v57
    v_cvt_pk_bf16_f32 v123, v58, v59
    buffer_store_dwordx4 v[120:123], v2, s[4:7], s45 offen offset:3072 sc1
    s_branch k2_fin
k2_loader:
    s_load_dwordx2 s[68:69], s[0:1], 16
    s_load_dwordx2 s[72:73], s[0:1], 56
    s_load_dwordx2 s[76:77], s[0:1], 0
    s_mov_b32 s70, 524288
    s_mov_b32 s71, 0x00020000
    s_mov_b32 s74, 917504
    s_mov_b32 s75, 0x00020000
    s_mov_b32 s78, 2097152
    s_mov_b32 s79, 0x00020000
    s_barrier
    s_cmp_ge_u32 s40, 2
    s_cbranch_scc1 k2_pref
    s_add_u32 m0, s29, 0
    s_mov_b64 exec, s[34:35]
    buffer_load_dwordx4 v17, s[4:7], s24 offen lds
    buffer_load_dwordx4 v17, s[4:7], s24 offen offset:1024 lds
    s_add_u32 m0, s30, 0
    s_mov_b64 exec, s[32:33]
    buffer_load_dwordx4 v18, s[4:7], s24 offen lds
    s_add_u32 m0, s30, 1024
    s_nop 0
    buffer_load_dwordx4 v18, s[4:7], s24 offen offset:1024 lds
    s_mov_b64 exec, -1
    s_add_u32 s24, s24, 2048
    s_waitcnt vmcnt(0)
    s_barrier
    s_add_u32 m0, s29, 30720
    s_mov_b64 exec, s[34:35]
    buffer_load_dwordx4 v17, s[4:7], s24 offen lds
    buffer_load_dwordx4 v17, s[4:7], s24 offen offset:1024 lds
    s_add_u32 m0, s30, 30720
    s_mov_b64 exec, s[32:33]
    buffer_load_dwordx4 v18, s[4:7], s24 offen lds
    s_add_u32 m0, s30, 31744
    s_nop 0
    buffer_load_dwordx4 v18, s[4:7], s24 offen offset:1024 lds
    s_mov_b64 exec, -1
    s_add_u32 s24, s24, 2048
    s_add_u32 m0, s29, 61440
    s_mov_b64 exec, s[34:35]
    buffer_load_dwordx4 v17, s[4:7], s24 offen lds
    buffer_load_dwordx4 v17, s[4:7], s24 offen offset:1024 lds
    s_add_u32 m0, s30, 61440
    s_mov_b64 exec, s[32:33]
    buffer_load_dwordx4 v18, s[4:7], s24 offen lds
    s_add_u32 m0, s30, 62464
    s_nop 0
    buffer_load_dwordx4 v18, s[4:7], s24 offen offset:1024 lds
    s_mov_b64 exec, -1
    s_add_u32 s24, s24, 2048
    s_add_u32 m0, s29, 92160
    s_mov_b64 exec, s[34:35]
    buffer_load_dwordx4 v17, s[4:7], s24 offen lds
    buffer_load_dwordx4 v17, s[4:7], s24 offen offset:1024 lds
    s_add_u32 m0, s30, 92160
    s_mov_b64 exec, s[32:33]
    buffer_load_dwordx4 v18, s[4:7], s24 offen lds
    s_add_u32 m0, s30, 93184
    s_nop 0
    buffer_load_dwordx4 v18, s[4:7], s24 offen offset:1024 lds
    s_mov_b64 exec, -1
    s_add_u32 s24, s24, 2048
    s_mov_b32 s26, 7
.p2align 6
fz_kernel_gloop38:
    s_waitcnt vmcnt(8) lgkmcnt(0)
    s_barrier
    s_add_u32 m0, s29, 0
    s_mov_b64 exec, s[34:35]
    buffer_load_dwordx4 v17, s[4:7], s24 offen lds
    buffer_load_dwordx4 v17, s[4:7], s24 offen offset:1024 lds
    s_add_u32 m0, s30, 0
    s_mov_b64 exec, s[32:33]
    buffer_load_dwordx4 v18, s[4:7], s24 offen lds
    s_add_u32 m0, s30, 1024
    s_nop 0
    buffer_load_dwordx4 v18, s[4:7], s24 offen offset:1024 lds
    s_mov_b64 exec, -1
    s_add_u32 s24, s24, 2048
    s_waitcnt vmcnt(8) lgkmcnt(0)
    s_barrier
    s_add_u32 m0, s29, 30720
    s_mov_b64 exec, s[34:35]
    buffer_load_dwordx4 v17, s[4:7], s24 offen lds
    buffer_load_dwordx4 v17, s[4:7], s24 offen offset:1024 lds
    s_add_u32 m0, s30, 30720
    s_mov_b64 exec, s[32:33]
    buffer_load_dwordx4 v18, s[4:7], s24 offen lds
    s_add_u32 m0, s30, 31744
    s_nop 0
    buffer_load_dwordx4 v18, s[4:7], s24 offen offset:1024 lds
    s_mov_b64 exec, -1
    s_add_u32 s24, s24, 2048
    s_waitcnt vmcnt(8) lgkmcnt(0)
    s_barrier
    s_add_u32 m0, s29, 61440
    s_mov_b64 exec, s[34:35]
    buffer_load_dwordx4 v17, s[4:7], s24 offen lds
    buffer_load_dwordx4 v17, s[4:7], s24 offen offset:1024 lds
    s_add_u32 m0, s30, 61440
    s_mov_b64 exec, s[32:33]
    buffer_load_dwordx4 v18, s[4:7], s24 offen lds
    s_add_u32 m0, s30, 62464
    s_nop 0
    buffer_load_dwordx4 v18, s[4:7], s24 offen offset:1024 lds
    s_mov_b64 exec, -1
    s_add_u32 s24, s24, 2048
    s_waitcnt vmcnt(8) lgkmcnt(0)
    s_barrier
    s_add_u32 m0, s29, 92160
    s_mov_b64 exec, s[34:35]
    buffer_load_dwordx4 v17, s[4:7], s24 offen lds
    buffer_load_dwordx4 v17, s[4:7], s24 offen offset:1024 lds
    s_add_u32 m0, s30, 92160
    s_mov_b64 exec, s[32:33]
    buffer_load_dwordx4 v18, s[4:7], s24 offen lds
    s_add_u32 m0, s30, 93184
    s_nop 0
    buffer_load_dwordx4 v18, s[4:7], s24 offen offset:1024 lds
    s_mov_b64 exec, -1
    s_add_u32 s24, s24, 2048
    s_sub_u32 s26, s26, 1
    s_cmp_lg_u32 s26, 0
    s_cbranch_scc1 fz_kernel_gloop38
    s_waitcnt vmcnt(8) lgkmcnt(0)
    s_barrier
    s_add_u32 m0, s96, 122880
    s_mov_b32 s97, 327680
    buffer_load_dwordx4 v126, s[68:71], s97 offen lds
    s_add_u32 m0, s96, 126976
    s_mov_b32 s97, 163840
    buffer_load_dwordx4 v126, s[72:75], s97 offen lds
    s_add_u32 m0, s96, 131072
    s_mov_b32 s97, 524288
    buffer_load_dwordx4 v126, s[72:75], s97 offen lds
    s_add_u32 m0, s96, 135168
    s_mov_b32 s97, 884736
    buffer_load_dwordx4 v126, s[72:75], s97 offen lds
    s_add_u32 m0, s96, 139264
    s_mov_b32 s97, 688128
    buffer_load_dwordx4 v126, s[72:75], s97 offen lds
    s_add_u32 m0, s96, 143360
    s_mov_b32 s97, 720896
    buffer_load_dwordx4 v126, s[72:75], s97 offen lds
    s_add_u32 m0, s96, 147456
    s_mov_b32 s97, 753664
    buffer_load_dwordx4 v126, s[72:75], s97 offen lds
    s_add_u32 m0, s96, 151552
    s_mov_b32 s97, 786432
    buffer_load_dwordx4 v126, s[72:75], s97 offen lds
    s_add_u32 m0, s96, 155648
    s_mov_b32 s97, 819200
    buffer_load_dwordx4 v126, s[72:75], s97 offen lds
    s_add_u32 m0, s96, 159744
    s_mov_b32 s97, 851968
    buffer_load_dwordx4 v126, s[72:75], s97 offen lds
    s_waitcnt vmcnt(14) lgkmcnt(0)
    s_barrier
    s_add_u32 m0, s96, 32768
    s_mov_b32 s97, 262144
    buffer_load_dwordx4 v126, s[68:71], s97 offen lds
    s_add_u32 m0, s96, 36864
    s_mov_b32 s97, 294912
    buffer_load_dwordx4 v126, s[68:71], s97 offen lds
    s_add_u32 m0, s96, 40960
    s_mov_b32 s97, 360448
    buffer_load_dwordx4 v126, s[68:71], s97 offen lds
    s_add_u32 m0, s96, 45056
    s_mov_b32 s97, 393216
    buffer_load_dwordx4 v126, s[68:71], s97 offen lds
    s_add_u32 m0, s96, 49152
    s_mov_b32 s97, 425984
    buffer_load_dwordx4 v126, s[68:71], s97 offen lds
    s_add_u32 m0, s96, 53248
    s_mov_b32 s97, 458752
    buffer_load_dwordx4 v126, s[68:71], s97 offen lds
    s_add_u32 m0, s96, 57344
    s_mov_b32 s97, 491520
    buffer_load_dwordx4 v126, s[68:71], s97 offen lds
    s_waitcnt vmcnt(17) lgkmcnt(0)
    s_barrier
    s_add_u32 m0, s96, 61440
    s_mov_b32 s97, 0
    buffer_load_dwordx4 v126, s[72:75], s97 offen lds
    s_add_u32 m0, s96, 65536
    s_mov_b32 s97, 32768
    buffer_load_dwordx4 v126, s[72:75], s97 offen lds
    s_add_u32 m0, s96, 69632
    s_mov_b32 s97, 65536
    buffer_load_dwordx4 v126, s[72:75], s97 offen lds
    s_add_u32 m0, s96, 73728
    s_mov_b32 s97, 98304
    buffer_load_dwordx4 v126, s[72:75], s97 offen lds
    s_add_u32 m0, s96, 77824
    s_mov_b32 s97, 131072
    buffer_load_dwordx4 v126, s[72:75], s97 offen lds
    s_add_u32 m0, s96, 81920
    s_mov_b32 s97, 196608
    buffer_load_dwordx4 v126, s[72:75], s97 offen lds
    s_add_u32 m0, s96, 86016
    s_mov_b32 s97, 229376
    buffer_load_dwordx4 v126, s[72:75], s97 offen lds
    s_waitcnt vmcnt(63) lgkmcnt(0)
    s_barrier
    s_add_u32 m0, s96, 90112
    s_mov_b32 s97, 262144
    buffer_load_dwordx4 v126, s[72:75], s97 offen lds
    s_add_u32 m0, s96, 94208
    s_mov_b32 s97, 294912
    buffer_load_dwordx4 v126, s[72:75], s97 offen lds
    s_add_u32 m0, s96, 98304
    s_mov_b32 s97, 327680
    buffer_load_dwordx4 v126, s[72:75], s97 offen lds
    s_add_u32 m0, s96, 102400
    s_mov_b32 s97, 360448
    buffer_load_dwordx4 v126, s[72:75], s97 offen lds
    s_add_u32 m0, s96, 106496
    s_mov_b32 s97, 393216
    buffer_load_dwordx4 v126, s[72:75], s97 offen lds
    s_add_u32 m0, s96, 110592
    s_mov_b32 s97, 425984
    buffer_load_dwordx4 v126, s[72:75], s97 offen lds
    s_add_u32 m0, s96, 114688
    s_mov_b32 s97, 458752
    buffer_load_dwordx4 v126, s[72:75], s97 offen lds
    s_add_u32 m0, s96, 118784
    s_mov_b32 s97, 491520
    buffer_load_dwordx4 v126, s[72:75], s97 offen lds
    s_branch k2_fin
k2_pref:
    s_sub_u32 s41, s21, 28
    s_lshl_b32 s41, s41, 1
    s_add_u32 s41, s41, s40
    s_sub_u32 s41, s41, 2
    s_lshl_b32 s84, s41, 16
    s_mul_i32 s85, s41, 114688
    s_lshl_b32 s86, s41, 15
    s_and_b32 s42, s2, 7
    s_lshl_b32 s42, s42, 18
    s_add_u32 s86, s86, s42
    v_lshlrev_b32 v4, 7, v1
    s_waitcnt lgkmcnt(0)
    s_barrier
    s_barrier
    s_barrier
    s_barrier
    s_barrier
    s_barrier
    s_barrier
    s_barrier
    s_barrier
    s_barrier
    s_barrier
    s_barrier
    s_barrier
    s_barrier
    s_barrier
    s_barrier
    s_barrier
    buffer_load_dword v28, v4, s[76:79], s86 offen
    s_add_u32 s86, s86, 8192
    buffer_load_dword v29, v4, s[76:79], s86 offen
    s_add_u32 s86, s86, 8192
    s_barrier
    buffer_load_dword v30, v4, s[76:79], s86 offen
    s_add_u32 s86, s86, 8192
    buffer_load_dword v31, v4, s[76:79], s86 offen
    s_add_u32 s86, s86, 8192
    s_barrier
    buffer_load_dword v32, v4, s[72:75], s85 offen
    s_add_u32 s85, s85, 8192
    buffer_load_dword v33, v4, s[72:75], s85 offen
    s_add_u32 s85, s85, 8192
    s_barrier
    buffer_load_dword v34, v4, s[72:75], s85 offen
    s_add_u32 s85, s85, 8192
    buffer_load_dword v35, v4, s[72:75], s85 offen
    s_add_u32 s85, s85, 8192
    s_barrier
    buffer_load_dword v36, v4, s[72:75], s85 offen
    s_add_u32 s85, s85, 8192
    buffer_load_dword v37, v4, s[72:75], s85 offen
    s_add_u32 s85, s85, 8192
    s_barrier
    buffer_load_dword v38, v4, s[72:75], s85 offen
    s_add_u32 s85, s85, 8192
    buffer_load_dword v39, v4, s[72:75], s85 offen
    s_add_u32 s85, s85, 8192
    s_barrier
    buffer_load_dword v40, v4, s[72:75], s85 offen
    s_add_u32 s85, s85, 8192
    buffer_load_dword v41, v4, s[72:75], s85 offen
    s_add_u32 s85, s85, 8192
    s_barrier
    buffer_load_dword v42, v4, s[72:75], s85 offen
    s_add_u32 s85, s85, 8192
    buffer_load_dword v43, v4, s[72:75], s85 offen
    s_add_u32 s85, s85, 8192
    s_barrier
    buffer_load_dword v44, v4, s[72:75], s85 offen
    s_add_u32 s85, s85, 8192
    buffer_load_dword v45, v4, s[72:75], s85 offen
    s_add_u32 s85, s85, 8192
    s_barrier
    buffer_load_dword v46, v4, s[68:71], s84 offen
    s_add_u32 s84, s84, 8192
    buffer_load_dword v47, v4, s[68:71], s84 offen
    s_add_u32 s84, s84, 8192
    s_barrier
    buffer_load_dword v48, v4, s[68:71], s84 offen
    s_add_u32 s84, s84, 8192
    buffer_load_dword v49, v4, s[68:71], s84 offen
    s_add_u32 s84, s84, 8192
    s_barrier
    buffer_load_dword v50, v4, s[68:71], s84 offen
    s_add_u32 s84, s84, 8192
    buffer_load_dword v51, v4, s[68:71], s84 offen
    s_add_u32 s84, s84, 8192
    s_barrier
    buffer_load_dword v52, v4, s[68:71], s84 offen
    s_add_u32 s84, s84, 8192
    buffer_load_dword v53, v4, s[68:71], s84 offen
    s_add_u32 s84, s84, 8192
    s_barrier
    s_add_u32 m0, s96, 122880
    s_mov_b32 s97, 327680
    buffer_load_dwordx4 v126, s[68:71], s97 offen lds
    s_add_u32 m0, s96, 126976
    s_mov_b32 s97, 163840
    buffer_load_dwordx4 v126, s[72:75], s97 offen lds
    s_add_u32 m0, s96, 131072
    s_mov_b32 s97, 524288
    buffer_load_dwordx4 v126, s[72:75], s97 offen lds
    s_add_u32 m0, s96, 135168
    s_mov_b32 s97, 884736
    buffer_load_dwordx4 v126, s[72:75], s97 offen lds
    s_add_u32 m0, s96, 139264
    s_mov_b32 s97, 688128
    buffer_load_dwordx4 v126, s[72:75], s97 offen lds
    s_add_u32 m0, s96, 143360
    s_mov_b32 s97, 720896
    buffer_load_dwordx4 v126, s[72:75], s97 offen lds
    s_add_u32 m0, s96, 147456
    s_mov_b32 s97, 753664
    buffer_load_dwordx4 v126, s[72:75], s97 offen lds
    s_add_u32 m0, s96, 151552
    s_mov_b32 s97, 786432
    buffer_load_dwordx4 v126, s[72:75], s97 offen lds
    s_add_u32 m0, s96, 155648
    s_mov_b32 s97, 819200
    buffer_load_dwordx4 v126, s[72:75], s97 offen lds
    s_add_u32 m0, s96, 159744
    s_mov_b32 s97, 851968
    buffer_load_dwordx4 v126, s[72:75], s97 offen lds
    s_barrier
    s_add_u32 m0, s96, 32768
    s_mov_b32 s97, 262144
    buffer_load_dwordx4 v126, s[68:71], s97 offen lds
    s_add_u32 m0, s96, 36864
    s_mov_b32 s97, 294912
    buffer_load_dwordx4 v126, s[68:71], s97 offen lds
    s_add_u32 m0, s96, 40960
    s_mov_b32 s97, 360448
    buffer_load_dwordx4 v126, s[68:71], s97 offen lds
    s_add_u32 m0, s96, 45056
    s_mov_b32 s97, 393216
    buffer_load_dwordx4 v126, s[68:71], s97 offen lds
    s_add_u32 m0, s96, 49152
    s_mov_b32 s97, 425984
    buffer_load_dwordx4 v126, s[68:71], s97 offen lds
    s_add_u32 m0, s96, 53248
    s_mov_b32 s97, 458752
    buffer_load_dwordx4 v126, s[68:71], s97 offen lds
    s_add_u32 m0, s96, 57344
    s_mov_b32 s97, 491520
    buffer_load_dwordx4 v126, s[68:71], s97 offen lds
    s_barrier
    s_add_u32 m0, s96, 61440
    s_mov_b32 s97, 0
    buffer_load_dwordx4 v126, s[72:75], s97 offen lds
    s_add_u32 m0, s96, 65536
    s_mov_b32 s97, 32768
    buffer_load_dwordx4 v126, s[72:75], s97 offen lds
    s_add_u32 m0, s96, 69632
    s_mov_b32 s97, 65536
    buffer_load_dwordx4 v126, s[72:75], s97 offen lds
    s_add_u32 m0, s96, 73728
    s_mov_b32 s97, 98304
    buffer_load_dwordx4 v126, s[72:75], s97 offen lds
    s_add_u32 m0, s96, 77824
    s_mov_b32 s97, 131072
    buffer_load_dwordx4 v126, s[72:75], s97 offen lds
    s_add_u32 m0, s96, 81920
    s_mov_b32 s97, 196608
    buffer_load_dwordx4 v126, s[72:75], s97 offen lds
    s_add_u32 m0, s96, 86016
    s_mov_b32 s97, 229376
    buffer_load_dwordx4 v126, s[72:75], s97 offen lds
    s_barrier
    s_add_u32 m0, s96, 90112
    s_mov_b32 s97, 262144
    buffer_load_dwordx4 v126, s[72:75], s97 offen lds
    s_add_u32 m0, s96, 94208
    s_mov_b32 s97, 294912
    buffer_load_dwordx4 v126, s[72:75], s97 offen lds
    s_add_u32 m0, s96, 98304
    s_mov_b32 s97, 327680
    buffer_load_dwordx4 v126, s[72:75], s97 offen lds
    s_add_u32 m0, s96, 102400
    s_mov_b32 s97, 360448
    buffer_load_dwordx4 v126, s[72:75], s97 offen lds
    s_add_u32 m0, s96, 106496
    s_mov_b32 s97, 393216
    buffer_load_dwordx4 v126, s[72:75], s97 offen lds
    s_add_u32 m0, s96, 110592
    s_mov_b32 s97, 425984
    buffer_load_dwordx4 v126, s[72:75], s97 offen lds
    s_add_u32 m0, s96, 114688
    s_mov_b32 s97, 458752
    buffer_load_dwordx4 v126, s[72:75], s97 offen lds
    s_add_u32 m0, s96, 118784
    s_mov_b32 s97, 491520
    buffer_load_dwordx4 v126, s[72:75], s97 offen lds
k2_fin:
    s_waitcnt vmcnt(0) lgkmcnt(0)
    s_barrier
    s_cmp_lg_u32 s16, 8
    s_cbranch_scc1 fz_kernel_noarr40
    s_lshl_b32 s36, s2, 6
    s_add_u32 s36, s36, 24133632
    v_mov_b32 v4, s99
    v_mov_b32 v5, 0
    s_mov_b64 exec, 1
    buffer_store_dword v4, v5, s[4:7], s36 offen sc0 sc1
    s_mov_b64 exec, -1
fz_kernel_noarr40:
    s_setprio 0
    s_load_dwordx2 s[16:17], s[0:1], 0
    s_load_dwordx2 s[20:21], s[0:1], 64
    v_lshrrev_b32 v8, 6, v0
    v_and_b32 v1, 63, v0
    v_readfirstlane_b32 s24, v8
    v_lshlrev_b32 v2, 4, v1
    s_and_b32 s36, s2, 7
    s_lshr_b32 s37, s2, 3
    s_lshl_b32 s27, s36, 2
    s_lshr_b32 s38, s37, 3
    s_add_u32 s27, s27, s38
    s_and_b32 s28, s37, 7
    s_mov_b32 s18, 2097152
    s_mov_b32 s19, 0x00020000
    s_mov_b32 s22, 2097152
    s_mov_b32 s23, 0x00020000
    s_cmp_ge_u32 s24, 8
    s_cbranch_scc1 k3_loader
    s_lshr_b32 s25, s24, 1
    s_and_b32 s26, s24, 1
    v_bfe_u32 v8, v1, 2, 2
    v_lshrrev_b32 v9, 5, v1
    v_lshl_add_u32 v9, v9, 3, v8
    v_bfe_u32 v10, v1, 4, 1
    v_lshlrev_b32 v10, 1, v10
    v_and_b32 v11, 1, v1
    v_or_b32 v10, v10, v11
    v_lshlrev_b32 v8, 1, v8
    v_and_b32 v8, 4, v8
    v_xor_b32 v10, v10, v8
    v_lshlrev_b32 v10, 4, v10
    v_lshl_add_u32 v10, v9, 7, v10
    v_bfe_u32 v11, v1, 1, 1
    v_lshl_add_u32 v10, v11, 3, v10
    s_lshl_b32 s36, s25, 12
    s_add_u32 s36, s36, 122880
    v_add_u32 v5, s36, v10
    v_xor_b32 v6, 64, v5
    ds_read_b64_tr_b16 v[100:101], v5 offset:0
    ds_read_b64_tr_b16 v[102:103], v5 offset:512
    ds_read_b64_tr_b16 v[104:105], v6 offset:0
    ds_read_b64_tr_b16 v[106:107], v6 offset:512
    ds_read_b64_tr_b16 v[108:109], v5 offset:2048
    ds_read_b64_tr_b16 v[110:111], v5 offset:2560
    ds_read_b64_tr_b16 v[112:113], v6 offset:2048
    ds_read_b64_tr_b16 v[114:115], v6 offset:2560
    s_mul_i32 s36, s25, 40960
    v_add_u32 v3, s36, v10
    v_xor_b32 v4, 64, v3
    s_lshl_b32 s36, s27, 1
    s_add_u32 s36, s36, s26
    s_lshl_b32 s37, s36, 15
    s_add_u32 s37, s37, 14680064
    s_mul_i32 s38, s36, 57344
    s_add_u32 s38, s38, 16744448
    s_mul_i32 s39, s25, 22528
    s_cmp_lt_u32 s25, 2
    s_cselect_b32 s29, s37, s38
    s_cmp_lt_u32 s25, 1
    s_cselect_b32 s30, s37, s38
    s_add_u32 s29, s29, s39
    s_add_u32 s30, s30, s39
    v_and_b32 v8, 31, v1
    v_lshlrev_b32 v8, 10, v8
    v_lshrrev_b32 v9, 5, v1
    v_lshl_add_u32 v8, v9, 4, v8
    s_lshl_b32 s40, s36, 15
    s_lshl_b32 s41, s28, 7
    s_add_u32 s40, s40, s41
    s_lshl_b32 s41, s25, 5
    s_add_u32 s40, s40, s41
    v_add_u32 v7, s40, v8
    s_waitcnt lgkmcnt(0)
    buffer_load_dwordx4 v[16:19], v7, s[16:19], 0 offen
    s_barrier
    s_barrier
    s_add_u32 s36, s29, 0
    buffer_load_dwordx4 v[116:119], v2, s[4:7], s36 offen offset:0
    buffer_load_dwordx4 v[120:123], v2, s[4:7], s36 offen offset:1024
    buffer_load_dwordx4 v[124:127], v2, s[4:7], s36 offen offset:2048
    buffer_load_dwordx4 v[128:131], v2, s[4:7], s36 offen offset:3072
    s_add_u32 s36, s29, 4096
    buffer_load_dwordx4 v[132:135], v2, s[4:7], s36 offen offset:0
    buffer_load_dwordx4 v[136:139], v2, s[4:7], s36 offen offset:1024
    buffer_load_dwordx4 v[140:143], v2, s[4:7], s36 offen offset:2048
    buffer_load_dwordx4 v[144:147], v2, s[4:7], s36 offen offset:3072
    s_add_u32 s36, s29, 8192
    buffer_load_dwordx4 v[148:151], v2, s[4:7], s36 offen offset:0
    buffer_load_dwordx4 v[152:155], v2, s[4:7], s36 offen offset:1024
    s_add_u32 s36, s30, 10240
    buffer_load_dwordx4 v[156:159], v2, s[4:7], s36 offen offset:0
    buffer_load_dwordx4 v[160:163], v2, s[4:7], s36 offen offset:1024
    ds_read_b64_tr_b16 v[84:85], v3 offset:0
    ds_read_b64_tr_b16 v[86:87], v3 offset:512
    ds_read_b64_tr_b16 v[88:89], v4 offset:0
    ds_read_b64_tr_b16 v[90:91], v4 offset:512
    ds_read_b64_tr_b16 v[92:93], v3 offset:2048
    ds_read_b64_tr_b16 v[94:95], v3 offset:2560
    ds_read_b64_tr_b16 v[96:97], v4 offset:2048
    ds_read_b64_tr_b16 v[98:99], v4 offset:2560
    s_waitcnt vmcnt(11) lgkmcnt(6)
    v_mfma_f32_32x32x16_bf16 v[20:35], v[84:87], v[116:119], 0
    s_waitcnt lgkmcnt(4)
    v_mfma_f32_32x32x16_bf16 v[36:51], v[88:91], v[116:119], 0
    s_add_u32 s36, s30, 12288
    buffer_load_dwordx4 v[116:119], v2, s[4:7], s36 offen offset:0
    ds_read_b64_tr_b16 v[84:85], v3 offset:4096
    ds_read_b64_tr_b16 v[86:87], v3 offset:4608
    ds_read_b64_tr_b16 v[88:89], v4 offset:4096
    ds_read_b64_tr_b16 v[90:91], v4 offset:4608
    s_waitcnt vmcnt(11) lgkmcnt(6)
    v_mfma_f32_32x32x16_bf16 v[20:35], v[92:95], v[120:123], v[20:35]
    s_waitcnt lgkmcnt(4)
    v_mfma_f32_32x32x16_bf16 v[36:51], v[96:99], v[120:123], v[36:51]
    buffer_load_dwordx4 v[120:123], v2, s[4:7], s36 offen offset:1024
    ds_read_b64_tr_b16 v[92:93], v3 offset:6144
    ds_read_b64_tr_b16 v[94:95], v3 offset:6656
    ds_read_b64_tr_b16 v[96:97], v4 offset:6144
    ds_read_b64_tr_b16 v[98:99], v4 offset:6656
    s_waitcnt vmcnt(11) lgkmcnt(6)
    v_mfma_f32_32x32x16_bf16 v[20:35], v[84:87], v[124:127], v[20:35]
    s_waitcnt lgkmcnt(4)
    v_mfma_f32_32x32x16_bf16 v[36:51], v[88:91], v[124:127], v[36:51]
    buffer_load_dwordx4 v[124:127], v2, s[4:7], s36 offen offset:2048
    ds_read_b64_tr_b16 v[84:85], v3 offset:8192
    ds_read_b64_tr_b16 v[86:87], v3 offset:8704
    ds_read_b64_tr_b16 v[88:89], v4 offset:8192
    ds_read_b64_tr_b16 v[90:91], v4 offset:8704
    s_waitcnt vmcnt(11) lgkmcnt(6)
    v_mfma_f32_32x32x16_bf16 v[20:35], v[92:95], v[128:131], v[20:35]
    s_waitcnt lgkmcnt(4)
    v_mfma_f32_32x32x16_bf16 v[36:51], v[96:99], v[128:131], v[36:51]
    buffer_load_dwordx4 v[128:131], v2, s[4:7], s36 offen offset:3072
    ds_read_b64_tr_b16 v[92:93], v3 offset:10240
    ds_read_b64_tr_b16 v[94:95], v3 offset:10752
    ds_read_b64_tr_b16 v[96:97], v4 offset:10240
    ds_read_b64_tr_b16 v[98:99], v4 offset:10752
    s_waitcnt vmcnt(11) lgkmcnt(6)
    v_mfma_f32_32x32x16_bf16 v[20:35], v[84:87], v[132:135], v[20:35]
    s_waitcnt lgkmcnt(4)
    v_mfma_f32_32x32x16_bf16 v[36:51], v[88:91], v[132:135], v[36:51]
    s_add_u32 s36, s30, 16384
    buffer_load_dwordx4 v[132:135], v2, s[4:7], s36 offen offset:0
    ds_read_b64_tr_b16 v[84:85], v3 offset:12288
    ds_read_b64_tr_b16 v[86:87], v3 offset:12800
    ds_read_b64_tr_b16 v[88:89], v4 offset:12288
    ds_read_b64_tr_b16 v[90:91], v4 offset:12800
    s_waitcnt vmcnt(11) lgkmcnt(6)
    v_mfma_f32_32x32x16_bf16 v[20:35], v[92:95], v[136:139], v[20:35]
    s_waitcnt lgkmcnt(4)
    v_mfma_f32_32x32x16_bf16 v[36:51], v[96:99], v[136:139], v[36:51]
    buffer_load_dwordx4 v[136:139], v2, s[4:7], s36 offen offset:1024
    ds_read_b64_tr_b16 v[92:93], v3 offset:14336
    ds_read_b64_tr_b16 v[94:95], v3 offset:14848
    ds_read_b64_tr_b16 v[96:97], v4 offset:14336
    ds_read_b64_tr_b16 v[98:99], v4 offset:14848
    s_waitcnt vmcnt(11) lgkmcnt(6)
    v_mfma_f32_32x32x16_bf16 v[20:35], v[84:87], v[140:143], v[20:35]
    s_waitcnt lgkmcnt(4)
    v_mfma_f32_32x32x16_bf16 v[36:51], v[88:91], v[140:143], v[36:51]
    buffer_load_dwordx4 v[140:143], v2, s[4:7], s36 offen offset:2048
    ds_read_b64_tr_b16 v[84:85], v3 offset:16384
    ds_read_b64_tr_b16 v[86:87], v3 offset:16896
    ds_read_b64_tr_b16 v[88:89], v4 offset:16384
    ds_read_b64_tr_b16 v[90:91], v4 offset:16896
    s_waitcnt vmcnt(11) lgkmcnt(6)
    v_mfma_f32_32x32x16_bf16 v[20:35], v[92:95], v[144:147], v[20:35]
    s_waitcnt lgkmcnt(4)
    v_mfma_f32_32x32x16_bf16 v[36:51], v[96:99], v[144:147], v[36:51]
    buffer_load_dwordx4 v[144:147], v2, s[4:7], s36 offen offset:3072
    ds_read_b64_tr_b16 v[92:93], v3 offset:18432
    ds_read_b64_tr_b16 v[94:95], v3 offset:18944
    ds_read_b64_tr_b16 v[96:97], v4 offset:18432
    ds_read_b64_tr_b16 v[98:99], v4 offset:18944
    s_waitcnt vmcnt(11) lgkmcnt(6)
    v_mfma_f32_32x32x16_bf16 v[20:35], v[84:87], v[148:151], v[20:35]
    s_waitcnt lgkmcnt(4)
    v_mfma_f32_32x32x16_bf16 v[36:51], v[88:91], v[148:151], v[36:51]
    s_add_u32 s36, s30, 20480
    buffer_load_dwordx4 v[148:151], v2, s[4:7], s36 offen offset:0
    ds_read_b64_tr_b16 v[84:85], v3 offset:20480
    ds_read_b64_tr_b16 v[86:87], v3 offset:20992
    ds_read_b64_tr_b16 v[88:89], v4 offset:20480
    ds_read_b64_tr_b16 v[90:91], v4 offset:20992
    s_waitcnt vmcnt(11) lgkmcnt(6)
    v_mfma_f32_32x32x16_bf16 v[20:35], v[92:95], v[152:155], v[20:35]
    s_waitcnt lgkmcnt(4)
    v_mfma_f32_32x32x16_bf16 v[36:51], v[96:99], v[152:155], v[36:51]
    buffer_load_dwordx4 v[152:155], v2, s[4:7], s36 offen offset:1024
    ds_read_b64_tr_b16 v[92:93], v3 offset:22528
    ds_read_b64_tr_b16 v[94:95], v3 offset:23040
    ds_read_b64_tr_b16 v[96:97], v4 offset:22528
    ds_read_b64_tr_b16 v[98:99], v4 offset:23040
    s_waitcnt vmcnt(11) lgkmcnt(6)
    v_mfma_f32_32x32x16_bf16 v[52:67], v[84:87], v[156:159], 0
    s_waitcnt lgkmcnt(4)
    v_mfma_f32_32x32x16_bf16 v[68:83], v[88:91], v[156:159], 0
    ds_read_b64_tr_b16 v[84:85], v3 offset:24576
    ds_read_b64_tr_b16 v[86:87], v3 offset:25088
    ds_read_b64_tr_b16 v[88:89], v4 offset:24576
    ds_read_b64_tr_b16 v[90:91], v4 offset:25088
    s_waitcnt vmcnt(10) lgkmcnt(6)
    v_mfma_f32_32x32x16_bf16 v[52:67], v[92:95], v[160:163], v[52:67]
    s_waitcnt lgkmcnt(4)
    v_mfma_f32_32x32x16_bf16 v[68:83], v[96:99], v[160:163], v[68:83]
    ds_read_b64_tr_b16 v[92:93], v3 offset:26624
    ds_read_b64_tr_b16 v[94:95], v3 offset:27136
    ds_read_b64_tr_b16 v[96:97], v4 offset:26624
    ds_read_b64_tr_b16 v[98:99], v4 offset:27136
    s_waitcnt vmcnt(9) lgkmcnt(6)
    v_mfma_f32_32x32x16_bf16 v[52:67], v[84:87], v[116:119], v[52:67]
    s_waitcnt lgkmcnt(4)
    v_mfma_f32_32x32x16_bf16 v[68:83], v[88:91], v[116:119], v[68:83]
    ds_read_b64_tr_b16 v[84:85], v3 offset:28672
    ds_read_b64_tr_b16 v[86:87], v3 offset:29184
    ds_read_b64_tr_b16 v[88:89], v4 offset:28672
    ds_read_b64_tr_b16 v[90:91], v4 offset:29184
    s_waitcnt vmcnt(8) lgkmcnt(6)
    v_mfma_f32_32x32x16_bf16 v[52:67], v[92:95], v[120:123], v[52:67]
    s_waitcnt lgkmcnt(4)
    v_mfma_f32_32x32x16_bf16 v[68:83], v[96:99], v[120:123], v[68:83]
    ds_read_b64_tr_b16 v[92:93], v3 offset:30720
    ds_read_b64_tr_b16 v[94:95], v3 offset:31232
    ds_read_b64_tr_b16 v[96:97], v4 offset:30720
    ds_read_b64_tr_b16 v[98:99], v4 offset:31232
    s_waitcnt vmcnt(7) lgkmcnt(6)
    v_mfma_f32_32x32x16_bf16 v[52:67], v[84:87], v[124:127], v[52:67]
    s_waitcnt lgkmcnt(4)
    v_mfma_f32_32x32x16_bf16 v[68:83], v[88:91], v[124:127], v[68:83]
    ds_read_b64_tr_b16 v[84:85], v3 offset:32768
    ds_read_b64_tr_b16 v[86:87], v3 offset:33280
    ds_read_b64_tr_b16 v[88:89], v4 offset:32768
    ds_read_b64_tr_b16 v[90:91], v4 offset:33280
    s_waitcnt vmcnt(6) lgkmcnt(6)
    v_mfma_f32_32x32x16_bf16 v[52:67], v[92:95], v[128:131], v[52:67]
    s_waitcnt lgkmcnt(4)
    v_mfma_f32_32x32x16_bf16 v[68:83], v[96:99], v[128:131], v[68:83]
    ds_read_b64_tr_b16 v[92:93], v3 offset:34816
    ds_read_b64_tr_b16 v[94:95], v3 offset:35328
    ds_read_b64_tr_b16 v[96:97], v4 offset:34816
    ds_read_b64_tr_b16 v[98:99], v4 offset:35328
    s_waitcnt vmcnt(5) lgkmcnt(6)
    v_mfma_f32_32x32x16_bf16 v[52:67], v[84:87], v[132:135], v[52:67]
    s_waitcnt lgkmcnt(4)
    v_mfma_f32_32x32x16_bf16 v[68:83], v[88:91], v[132:135], v[68:83]
    ds_read_b64_tr_b16 v[84:85], v3 offset:36864
    ds_read_b64_tr_b16 v[86:87], v3 offset:37376
    ds_read_b64_tr_b16 v[88:89], v4 offset:36864
    ds_read_b64_tr_b16 v[90:91], v4 offset:37376
    s_waitcnt vmcnt(4) lgkmcnt(6)
    v_mfma_f32_32x32x16_bf16 v[52:67], v[92:95], v[136:139], v[52:67]
    s_waitcnt lgkmcnt(4)
    v_mfma_f32_32x32x16_bf16 v[68:83], v[96:99], v[136:139], v[68:83]
    ds_read_b64_tr_b16 v[92:93], v3 offset:38912
    ds_read_b64_tr_b16 v[94:95], v3 offset:39424
    ds_read_b64_tr_b16 v[96:97], v4 offset:38912
    ds_read_b64_tr_b16 v[98:99], v4 offset:39424
    s_waitcnt vmcnt(3) lgkmcnt(6)
    v_mfma_f32_32x32x16_bf16 v[52:67], v[84:87], v[140:143], v[52:67]
    s_waitcnt lgkmcnt(4)
    v_mfma_f32_32x32x16_bf16 v[68:83], v[88:91], v[140:143], v[68:83]
    s_waitcnt vmcnt(2) lgkmcnt(2)
    v_mfma_f32_32x32x16_bf16 v[52:67], v[92:95], v[144:147], v[52:67]
    s_waitcnt lgkmcnt(0)
    v_mfma_f32_32x32x16_bf16 v[68:83], v[96:99], v[144:147], v[68:83]
    s_waitcnt vmcnt(1)
    v_mfma_f32_32x32x16_bf16 v[52:67], v[100:103], v[148:151], v[52:67]
    v_mfma_f32_32x32x16_bf16 v[68:83], v[104:107], v[148:151], v[68:83]
    s_waitcnt vmcnt(0)
    v_mfma_f32_32x32x16_bf16 v[52:67], v[108:111], v[152:155], v[52:67]
    v_mfma_f32_32x32x16_bf16 v[68:83], v[112:115], v[152:155], v[68:83]
    s_barrier
    s_mul_i32 s36, s26, 40960
    v_lshlrev_b32 v8, 1, v2
    v_add_u32 v8, s36, v8
    s_cmp_eq_u32 s25, 1
    s_cbranch_scc1 k3_q1
    s_nop 4
    v_pk_add_f32 v[20:21], v[20:21], v[52:53]
    v_pk_add_f32 v[22:23], v[22:23], v[54:55]
    v_pk_add_f32 v[24:25], v[24:25], v[56:57]
    v_pk_add_f32 v[26:27], v[26:27], v[58:59]
    v_pk_add_f32 v[28:29], v[28:29], v[60:61]
    v_pk_add_f32 v[30:31], v[30:31], v[62:63]
    v_pk_add_f32 v[32:33], v[32:33], v[64:65]
    v_pk_add_f32 v[34:35], v[34:35], v[66:67]
    v_pk_add_f32 v[36:37], v[36:37], v[68:69]
    v_pk_add_f32 v[38:39], v[38:39], v[70:71]
    v_pk_add_f32 v[40:41], v[40:41], v[72:73]
    v_pk_add_f32 v[42:43], v[42:43], v[74:75]
    v_pk_add_f32 v[44:45], v[44:45], v[76:77]
    v_pk_add_f32 v[46:47], v[46:47], v[78:79]
    v_pk_add_f32 v[48:49], v[48:49], v[80:81]
    v_pk_add_f32 v[50:51], v[50:51], v[82:83]
    s_add_u32 s37, s25, 1
    s_cmp_eq_u32 s25, 0
    s_cselect_b32 s37, 0, s37
    s_lshl_b32 s37, s37, 13
    v_add_u32 v9, s37, v8
    ds_write_b128 v9, v[20:23] offset:0
    ds_write_b128 v9, v[24:27] offset:16
    ds_write_b128 v9, v[28:31] offset:2048
    ds_write_b128 v9, v[32:35] offset:2064
    ds_write_b128 v9, v[36:39] offset:4096
    ds_write_b128 v9, v[40:43] offset:4112
    ds_write_b128 v9, v[44:47] offset:6144
    ds_write_b128 v9, v[48:51] offset:6160
    s_branch k3_red
k3_q1:
    ds_write_b128 v8, v[20:23] offset:8192
    ds_write_b128 v8, v[24:27] offset:8208
    ds_write_b128 v8, v[28:31] offset:10240
    ds_write_b128 v8, v[32:35] offset:10256
    ds_write_b128 v8, v[36:39] offset:12288
    ds_write_b128 v8, v[40:43] offset:12304
    ds_write_b128 v8, v[44:47] offset:14336
    ds_write_b128 v8, v[48:51] offset:14352
    ds_write_b128 v8, v[52:55] offset:16384
    ds_write_b128 v8, v[56:59] offset:16400
    ds_write_b128 v8, v[60:63] offset:18432
    ds_write_b128 v8, v[64:67] offset:18448
    ds_write_b128 v8, v[68:71] offset:20480
    ds_write_b128 v8, v[72:75] offset:20496
    ds_write_b128 v8, v[76:79] offset:22528
    ds_write_b128 v8, v[80:83] offset:22544
k3_red:
    s_lshl_b32 s37, s25, 11
    v_add_u32 v9, s37, v8
    s_waitcnt lgkmcnt(0)
    s_barrier
    ds_read_b128 v[20:23], v9 offset:0
    ds_read_b128 v[24:27], v9 offset:16
    ds_read_b128 v[28:31], v9 offset:8192
    ds_read_b128 v[32:35], v9 offset:8208
    ds_read_b128 v[36:39], v9 offset:16384
    ds_read_b128 v[40:43], v9 offset:16400
    ds_read_b128 v[44:47], v9 offset:24576
    ds_read_b128 v[48:51], v9 offset:24592
    ds_read_b128 v[52:55], v9 offset:32768
    ds_read_b128 v[56:59], v9 offset:32784
    v_lshlrev_b32 v68, 16, v16
    v_and_b32 v69, 0xffff0000, v16
    v_lshlrev_b32 v70, 16, v17
    v_and_b32 v71, 0xffff0000, v17
    v_lshlrev_b32 v72, 16, v18
    v_and_b32 v73, 0xffff0000, v18
    v_lshlrev_b32 v74, 16, v19
    v_and_b32 v75, 0xffff0000, v19
    s_mov_b32 s36, 0xbfb8aa3b
    s_waitcnt lgkmcnt(7)
    v_pk_add_f32 v[20:21], v[20:21], v[28:29]
    v_pk_add_f32 v[22:23], v[22:23], v[30:31]
    s_waitcnt lgkmcnt(6)
    v_pk_add_f32 v[24:25], v[24:25], v[32:33]
    v_pk_add_f32 v[26:27], v[26:27], v[34:35]
    s_waitcnt lgkmcnt(3)
    v_pk_add_f32 v[36:37], v[36:37], v[44:45]
    v_pk_add_f32 v[38:39], v[38:39], v[46:47]
    s_waitcnt lgkmcnt(2)
    v_pk_add_f32 v[40:41], v[40:41], v[48:49]
    v_pk_add_f32 v[42:43], v[42:43], v[50:51]
    s_waitcnt lgkmcnt(1)
    v_pk_add_f32 v[36:37], v[36:37], v[52:53]
    v_pk_add_f32 v[38:39], v[38:39], v[54:55]
    s_waitcnt lgkmcnt(0)
    v_pk_add_f32 v[40:41], v[40:41], v[56:57]
    v_pk_add_f32 v[42:43], v[42:43], v[58:59]
    v_mul_f32 v60, s36, v36
    v_mul_f32 v61, s36, v37
    v_mul_f32 v62, s36, v38
    v_mul_f32 v63, s36, v39
    v_mul_f32 v64, s36, v40
    v_mul_f32 v65, s36, v41
    v_mul_f32 v66, s36, v42
    v_mul_f32 v67, s36, v43
    v_exp_f32 v60, v60
    v_exp_f32 v61, v61
    v_exp_f32 v62, v62
    v_exp_f32 v63, v63
    v_exp_f32 v64, v64
    v_exp_f32 v65, v65
    v_exp_f32 v66, v66
    v_exp_f32 v67, v67
    v_pk_mul_f32 v[36:37], v[36:37], v[20:21]
    v_pk_mul_f32 v[38:39], v[38:39], v[22:23]
    v_pk_mul_f32 v[40:41], v[40:41], v[24:25]
    v_pk_mul_f32 v[42:43], v[42:43], v[26:27]
    v_add_f32 v60, 1.0, v60
    v_add_f32 v61, 1.0, v61
    v_add_f32 v62, 1.0, v62
    v_add_f32 v63, 1.0, v63
    v_add_f32 v64, 1.0, v64
    v_add_f32 v65, 1.0, v65
    v_add_f32 v66, 1.0, v66
    v_add_f32 v67, 1.0, v67
    v_rcp_f32 v60, v60
    v_rcp_f32 v61, v61
    v_rcp_f32 v62, v62
    v_rcp_f32 v63, v63
    v_rcp_f32 v64, v64
    v_rcp_f32 v65, v65
    v_rcp_f32 v66, v66
    v_rcp_f32 v67, v67
    v_pk_fma_f32 v[68:69], v[36:37], v[60:61], v[68:69]
    v_pk_fma_f32 v[70:71], v[38:39], v[62:63], v[70:71]
    v_pk_fma_f32 v[72:73], v[40:41], v[64:65], v[72:73]
    v_pk_fma_f32 v[74:75], v[42:43], v[66:67], v[74:75]
    v_cvt_pk_bf16_f32 v16, v68, v69
    v_cvt_pk_bf16_f32 v17, v70, v71
    v_cvt_pk_bf16_f32 v18, v72, v73
    v_cvt_pk_bf16_f32 v19, v74, v75
    buffer_store_dwordx4 v[16:19], v7, s[20:23], 0 offen
    s_branch k3_fin
k3_loader:
    s_setprio 3
    s_add_u32 m0, s96, 0
    s_mov_b32 s97, 0
    buffer_load_dwordx4 v126, s[68:71], s97 offen lds
    s_add_u32 m0, s96, 4096
    s_mov_b32 s97, 32768
    buffer_load_dwordx4 v126, s[68:71], s97 offen lds
    s_add_u32 m0, s96, 8192
    s_mov_b32 s97, 65536
    buffer_load_dwordx4 v126, s[68:71], s97 offen lds
    s_add_u32 m0, s96, 12288
    s_mov_b32 s97, 98304
    buffer_load_dwordx4 v126, s[68:71], s97 offen lds
    s_add_u32 m0, s96, 16384
    s_mov_b32 s97, 131072
    buffer_load_dwordx4 v126, s[68:71], s97 offen lds
    s_add_u32 m0, s96, 20480
    s_mov_b32 s97, 163840
    buffer_load_dwordx4 v126, s[68:71], s97 offen lds
    s_add_u32 m0, s96, 24576
    s_mov_b32 s97, 196608
    buffer_load_dwordx4 v126, s[68:71], s97 offen lds
    s_add_u32 m0, s96, 28672
    s_mov_b32 s97, 229376
    buffer_load_dwordx4 v126, s[68:71], s97 offen lds
    s_barrier
    s_add_u32 m0, s96, 122880
    s_mov_b32 s97, 557056
    buffer_load_dwordx4 v126, s[72:75], s97 offen lds
    s_add_u32 m0, s96, 126976
    s_mov_b32 s97, 589824
    buffer_load_dwordx4 v126, s[72:75], s97 offen lds
    s_add_u32 m0, s96, 131072
    s_mov_b32 s97, 622592
    buffer_load_dwordx4 v126, s[72:75], s97 offen lds
    s_add_u32 m0, s96, 135168
    s_mov_b32 s97, 655360
    buffer_load_dwordx4 v126, s[72:75], s97 offen lds
    s_cmp_lg_u32 s24, 8
    s_cbranch_scc1 fz_kernel_nowait41
    s_lshr_b32 s46, s27, 2
    s_lshl_b32 s46, s46, 3
    v_and_b32 v20, 3, v1
    v_lshlrev_b32 v20, 6, v20
    v_bfe_u32 v21, v1, 2, 3
    v_add3_u32 v20, v20, v21, s46
    v_subrev_u32 v21, 32, v1
    v_min_u32 v21, 13, v21
    v_cmp_lt_u32 vcc, 6, v21
    v_subrev_u32 v22, 7, v21
    s_nop 0
    v_cndmask_b32 v21, v21, v22, vcc
    v_lshlrev_b32 v21, 5, v21
    v_cndmask_b32 v22, 0, 4, vcc
    s_lshr_b32 s46, s27, 1
    s_and_b32 s47, s46, 3
    s_lshl_b32 s47, s47, 3
    s_lshr_b32 s46, s46, 2
    s_add_u32 s46, s46, s47
    v_add3_u32 v21, v21, v22, s46
    v_cmp_lt_u32 vcc, 31, v1
    s_nop 1
    v_cndmask_b32 v20, v20, v21, vcc
    v_lshlrev_b32 v20, 6, v20
    s_mov_b32 s47, 600000
    s_mov_b32 s46, 24133632
fz_kernel_gpoll42:
    buffer_load_dword v21, v20, s[4:7], s46 offen sc0 sc1
    s_waitcnt vmcnt(0)
    v_cmp_ne_u32 vcc, s99, v21
    s_nop 0
    s_cmp_eq_u64 vcc, 0
    s_cbranch_scc1 fz_kernel_nowait41
    s_sleep 1
    s_sub_u32 s47, s47, 1
    s_cbranch_scc0 fz_kernel_gpoll42
fz_kernel_nowait41:
    s_waitcnt vmcnt(0) lgkmcnt(0)
    s_barrier
    s_barrier
    s_barrier
k3_fin:
fz_end:
    s_endpgm

.section .rodata,"a"
.p2align 6
.amdhsa_kernel recurrent_scan__softmax_full_mha__mixer_gmlp__prompt_kernel
  .amdhsa_next_free_vgpr 167
  .amdhsa_next_free_sgpr 100
  .amdhsa_accum_offset 168
  .amdhsa_group_segment_fixed_size 0
  .amdhsa_kernarg_size 88
  .amdhsa_user_sgpr_count 2
  .amdhsa_user_sgpr_kernarg_segment_ptr 1
  .amdhsa_system_sgpr_workgroup_id_x 1
.end_amdhsa_kernel
```
